```python
import torch

def _softmax(x, axis=-1):
    return torch.softmax(x, dim=axis)
def _gelu(x):
    return torch.nn.functional.gelu(x, approximate="tanh")
def _silu(x):
    return torch.nn.functional.silu(x)
def _sigmoid(x):
    return torch.sigmoid(x)
def _layernorm(x, axis=-1, eps=1e-5):
    m = x.mean(dim=axis, keepdim=True)
    v = x.var(dim=axis, keepdim=True, unbiased=False)
    return (x - m) / torch.sqrt(v + eps)
def _scatter_add(tgt, idx, src, axis=0):
    return tgt.clone().index_add_(axis, idx, src)
def _segment_sum(src, seg, n):
    out = torch.zeros((n,) + src.shape[1:], dtype=src.dtype)
    return out.index_add_(0, seg, src)
def _pad(x, pw):
    flat = tuple(v for pair in reversed(pw) for v in pair)
    return torch.nn.functional.pad(x, flat)

kernel_name = 'parallel_sum__ssm_conv_s4__dense_activation_squared_relu__prompt'

def setup_inputs():

    _w = (lambda a: (lambda t: t.to(torch.bfloat16) if t.is_floating_point() else t)(torch.as_tensor(a)))
    def _A_setup():
        B, L, D, N = 1, 2048, 512, 128
        A_re = -(lambda _x: torch.exp(torch.as_tensor(_x)))((lambda *s: torch.randn(*s, dtype=torch.bfloat16) * 3.2)(D, N))
        A_im = torch.pi * (lambda *s: torch.randn(*s, dtype=torch.bfloat16) * 0.2)(D, N)
        B_re = (lambda *s: torch.randn(*s, dtype=torch.bfloat16) * 0.4)(D, N)
        B_im = (lambda *s: torch.randn(*s, dtype=torch.bfloat16) * 0.4)(D, N)
        C_re = (lambda *s: torch.randn(*s, dtype=torch.bfloat16) * 0.4)(D, N)
        C_im = (lambda *s: torch.randn(*s, dtype=torch.bfloat16) * 0.4)(D, N)
        log_dt = (lambda *s: torch.randn(*s, dtype=torch.bfloat16) * 0.2)(D) * 0.5 - 4.0
        Dskip = (lambda *s: torch.randn(*s, dtype=torch.bfloat16) * 0.4)(D)
        return {
            "u": _w((lambda *s: torch.randn(*s, dtype=torch.bfloat16) * 0.05)(B, L, D)),
            "A_re": _w(A_re),
            "A_im": _w(A_im),
            "B_re": _w(B_re),
            "B_im": _w(B_im),
            "C_re": _w(C_re),
            "C_im": _w(C_im),
            "log_dt": _w(log_dt),
            "Dskip": _w(Dskip),
        }
    _A_in = _A_setup()

    def _B_setup():
        B, S, D, F = 1, 2048, 512, 1376
        return {
            "x": _w((lambda *s: torch.randn(*s, dtype=torch.bfloat16) * 0.05)(B, S, D)),
            "w1": _w((lambda *s: torch.randn(*s, dtype=torch.bfloat16) * 0.05)(D, F)),
            "b1": _w((lambda *s: torch.randn(*s, dtype=torch.bfloat16) * 0.2)(F)),
            "w2": _w((lambda *s: torch.randn(*s, dtype=torch.bfloat16) * 0.05)(F, D)),
            "b2": _w((lambda *s: torch.randn(*s, dtype=torch.bfloat16) * 0.8)(D)),
        }
    _B_in = _B_setup()

    return {
        "A_u": _A_in["u"],
        "A_A_re": _A_in["A_re"],
        "A_A_im": _A_in["A_im"],
        "A_B_re": _A_in["B_re"],
        "A_B_im": _A_in["B_im"],
        "A_C_re": _A_in["C_re"],
        "A_C_im": _A_in["C_im"],
        "A_log_dt": _A_in["log_dt"],
        "A_Dskip": _A_in["Dskip"],
        "B_x": _B_in["x"],
        "B_w1": _B_in["w1"],
        "B_b1": _B_in["b1"],
        "B_w2": _B_in["w2"],
        "B_b2": _B_in["b2"],
    }

def reference(A_u, A_A_re, A_A_im, A_B_re, A_B_im, A_C_re, A_C_im, A_log_dt, A_Dskip, B_x, B_w1, B_b1, B_w2, B_b2):
    def _A_ref(u, A_re, A_im, B_re, B_im, C_re, C_im, log_dt, Dskip):
        Bsz, L, D = u.shape
        dt = torch.exp(log_dt)[:, None]
        A = A_re + 1j * A_im
        Bc = B_re + 1j * B_im
        Cc = C_re + 1j * C_im
        logdA = dt * A
        dB = dt * Bc
        l = (lambda x, dt: x.to(dt))(torch.arange(L), A_re.dtype)
        P = torch.exp(logdA[:, :, None] * l[None, None, :])
        K = torch.einsum("dn,dnl,dn->dl", Cc, P, dB).real
        L2 = 2 * L
        Kp = _pad(K, ((0, 0), (0, L)))
        up = (lambda x, *d: x.permute(*d))(u, 0, 2, 1)
        up = _pad(up, ((0, 0), (0, 0), (0, L)))
        Kf = (lambda x, axes=(-2,-1): torch.fft.rfft2(x.float(), dim=axes))(Kp[:, None, :], axes=(-2, -1))
        Uf = (lambda x, axes=(-2,-1): torch.fft.rfft2(x.float(), dim=axes))(up[:, :, None, :], axes=(-2, -1))
        Yf = Uf * Kf[None, :, :, :]
        y = (lambda x, s, axes=(-2,-1): torch.fft.irfft2(x, s=s, dim=axes).to(torch.bfloat16))(Yf, (1, L2), axes=(-2, -1))[:, :, 0, :L]
        y = (lambda x, *d: x.permute(*d))(y, 0, 2, 1) + u * Dskip[None, None, :]
        return y

    def _B_ref(x, w1, b1, w2, b2):
        h = torch.einsum("bsd,df->bsf", x, w1) + b1
        zero = torch.zeros_like(h)
        r = torch.where(h > zero, h, zero)
        h = r * r
        out = torch.einsum("bsf,fd->bsd", h, w2) + b2
        return out

    x = A_u
    xn = _layernorm(x, axis=-1)
    return x + _A_ref(xn, A_A_re, A_A_im, A_B_re, A_B_im, A_C_re, A_C_im, A_log_dt, A_Dskip) + _B_ref(xn, B_w1, B_b1, B_w2, B_b2)
```

```asm
; @launch grid=(256,1,1) block=(512,1,1) lds=163840
.amdgcn_target "amdgcn-amd-amdhsa--gfx950"
.text
.globl parallel_sum__ssm_conv_s4__dense_activation_squared_relu__prompt_kernel
.p2align 8
.type parallel_sum__ssm_conv_s4__dense_activation_squared_relu__prompt_kernel,@function
parallel_sum__ssm_conv_s4__dense_activation_squared_relu__prompt_kernel:
    s_cmp_ge_u32 s2, 256
    s_cbranch_scc1 L_end
    s_load_dwordx16 s[4:19], s[0:1], 0
    s_load_dwordx16 s[20:35], s[0:1], 64
    s_load_dwordx2 s[36:37], s[0:1], 128
    v_xor_b32 v0, 256, v0
    v_mov_b32 v1, v0
    v_lshrrev_b32 v3, 6, v0
    v_and_b32 v0, 63, v0
    v_readfirstlane_b32 s60, v3
    v_lshlrev_b32 v2, 4, v0
    s_and_b32 s61, s2, 7
    s_lshr_b32 s62, s2, 3
    s_lshl_b32 s74, s61, 5
    s_add_u32 s67, s74, s62
    s_lshl_b32 s66, s67, 3
    s_and_b32 s75, s62, 3
    s_lshr_b32 s76, s62, 2
    s_and_b32 s77, s61, 1
    s_lshl_b32 s78, s77, 3
    s_add_u32 s78, s78, s76
    s_lshl_b32 s77, s77, 1
    s_add_u32 s77, s77, s75
    s_cmp_eq_u32 s76, 7
    s_cselect_b32 s78, 7, s78
    s_cselect_b32 s77, s77, s75
    s_cmp_lt_u32 s62, 30
    s_cselect_b32 s70, 1, 0
    s_cselect_b32 s78, s78, 15
    s_cselect_b32 s77, s77, s75
    s_lshr_b32 s74, s61, 1
    s_lshl_b32 s74, s74, 2
    s_add_u32 s74, s74, s77
    s_lshl_b32 s68, s74, 7
    s_mul_i32 s69, s78, 96
    s_lshl_b32 s71, s67, 1
    s_lshl_b32 s74, s61, 8
    s_lshl_b32 s75, s75, 6
    s_add_u32 s72, s74, s75
    s_add_u32 s76, s76, 0
    s_and_b32 s76, s76, 7
    s_lshl_b32 s73, s76, 6
    s_waitcnt lgkmcnt(0)
    s_mov_b32 s40, s4
    s_mov_b32 s41, s5
    s_mov_b32 s42, 2097152
    s_mov_b32 s43, 0x20000
    s_mov_b32 s44, s24
    s_mov_b32 s45, s25
    s_mov_b32 s46, 1409024
    s_mov_b32 s47, 0x20000
    s_mov_b32 s48, s28
    s_mov_b32 s49, s29
    s_mov_b32 s50, 1409024
    s_mov_b32 s51, 0x20000
    s_mov_b32 s52, s36
    s_mov_b32 s53, s37
    s_mov_b32 s54, 33554432
    s_mov_b32 s55, 0x20000
    s_mov_b32 s56, s32
    s_mov_b32 s57, s33
    s_mov_b32 s58, 2097152
    s_mov_b32 s59, 0x20000
    s_cmp_ge_u32 s60, 4
    s_cbranch_scc0 L_roleC
    s_sub_u32 s92, s60, 4
    s_lshl_b32 s74, s92, 1
    s_add_u32 s74, s74, s66
    s_lshl_b32 s74, s74, 10
    buffer_load_dwordx4 v[4:7], v2, s[40:43], s74 offen
    buffer_load_dwordx4 v[8:11], v2, s[40:43], s74 offen offset:1024
    buffer_load_dword v3, off, s[52:55], 0 sc1
    s_lshr_b32 s93, s92, 1
    s_and_b32 s94, s92, 1
    s_add_u32 s74, s71, s93
    s_lshl_b32 s74, s74, 1
    v_mov_b32 v34, s74
    s_lshl_b32 s74, s62, 2
    s_add_u32 s74, s74, s92
    s_and_b32 s74, s74, 31
    s_lshl_b32 s74, s74, 10
    s_min_u32 s74, s74, L_end-parallel_sum__ssm_conv_s4__dense_activation_squared_relu__prompt_kernel-1024
    s_getpc_b64 s[88:89]
L_pc:
    s_sub_u32 s88, s88, L_pc-parallel_sum__ssm_conv_s4__dense_activation_squared_relu__prompt_kernel
    s_subb_u32 s89, s89, 0
    v_add_u32 v35, s74, v2
    global_load_dwordx4 v[168:171], v35, s[88:89]
    global_load_ushort v167, v34, s[20:21]
    v_lshlrev_b32 v33, 1, v0
    v_add_u32 v33, s69, v33
    v_min_u32 v33, 1374, v33
    v_lshlrev_b32 v33, 1, v33
    global_load_dword v188, v33, s[26:27]
    s_branch L_roleH
L_roleC:
    s_setprio 3
    s_sub_u32 s92, s60, 0
    s_lshr_b32 s93, s92, 1
    s_and_b32 s94, s92, 1
    s_add_u32 s74, s71, s93
    s_lshl_b32 s75, s74, 7
    s_lshl_b32 s76, s94, 6
    s_add_u32 s75, s75, s76
    v_add_u32 v33, s75, v0
    v_lshlrev_b32 v33, 1, v33
    s_lshl_b32 s74, s74, 1
    v_mov_b32 v34, s74
    global_load_ushort v160, v33, s[6:7]
    global_load_ushort v161, v33, s[8:9]
    global_load_ushort v162, v33, s[10:11]
    global_load_ushort v163, v33, s[12:13]
    global_load_ushort v164, v33, s[14:15]
    global_load_ushort v165, v33, s[16:17]
    global_load_ushort v166, v34, s[18:19]
    global_load_ushort v167, v34, s[20:21]
    buffer_load_dword v3, off, s[52:55], 0 sc1
    s_lshr_b32 s74, s62, 2
    s_and_b32 s75, s62, 3
    s_lshl_b32 s75, s75, 1
    s_add_u32 s74, s74, s75
    s_and_b32 s100, s74, 7
    s_cmp_ge_u32 s74, 10
    s_cselect_b32 s75, 10, 0
    s_sub_u32 s101, s74, s75
    s_cmp_ge_u32 s74, 7
    s_cselect_b32 s75, 7, 0
    s_sub_u32 s100, s74, s75
    s_lshr_b32 s74, s60, 1
    s_lshl_b32 s74, s74, 5
    s_add_u32 s74, s74, s73
    v_and_b32 v247, 31, v0
    v_add_u32 v247, s74, v247
    v_lshlrev_b32 v247, 1, v247
    global_load_ushort v248, v247, s[30:31]
    v_and_b32 v40, 31, v0
    v_lshrrev_b32 v41, 5, v0
    v_bfe_u32 v42, v0, 1, 3
    v_xor_b32 v42, v42, v41
    v_lshlrev_b32 v42, 4, v42
    v_lshl_add_u32 v42, v40, 7, v42
    s_lshl_b32 s74, s60, 12
    v_add_u32 v231, s74, v42
    v_xor_b32 v232, 32, v231
    v_xor_b32 v233, 64, v231
    v_xor_b32 v234, 96, v231
    v_bfe_u32 v42, v0, 2, 2
    v_lshl_add_u32 v42, v41, 3, v42
    v_mul_u32_u24 v42, 192, v42
    v_bfe_u32 v43, v0, 4, 1
    v_lshl_add_u32 v42, v43, 5, v42
    v_bfe_u32 v43, v0, 1, 1
    v_lshl_add_u32 v42, v43, 4, v42
    v_and_b32 v43, 1, v0
    v_lshl_add_u32 v42, v43, 3, v42
    v_add_u32 v42, 16384, v42
    s_add_u32 s74, s60, 0
    s_cmp_ge_u32 s74, 3
    s_cselect_b32 s75, 3, 0
    s_sub_u32 s74, s74, s75
    s_cmp_ge_u32 s74, 3
    s_cselect_b32 s75, 3, 0
    s_sub_u32 s74, s74, s75
    s_lshl_b32 s75, s74, 6
    v_add_u32 v228, s75, v42
    s_lshr_b32 s76, s68, 5
    s_add_u32 s76, s76, s60
    s_mul_i32 s76, s76, 86
    s_lshr_b32 s77, s69, 4
    s_lshl_b32 s78, s74, 1
    s_add_u32 s77, s77, s78
    s_add_u32 s76, s76, s77
    s_lshl_b32 s76, s76, 10
    s_add_u32 s76, s76, 9437184
    s_cmp_lt_u32 s77, 86
    s_cselect_b32 s85, s76, 2147418112
    s_lshl_b32 s75, s74, 7
    s_add_u32 s75, s75, 161472
    v_lshl_add_u32 v220, v41, 4, s75
    s_add_u32 s74, s60, 1
    s_cmp_ge_u32 s74, 3
    s_cselect_b32 s75, 3, 0
    s_sub_u32 s74, s74, s75
    s_cmp_ge_u32 s74, 3
    s_cselect_b32 s75, 3, 0
    s_sub_u32 s74, s74, s75
    s_lshl_b32 s75, s74, 6
    v_add_u32 v229, s75, v42
    s_lshr_b32 s76, s68, 5
    s_add_u32 s76, s76, s60
    s_mul_i32 s76, s76, 86
    s_lshr_b32 s77, s69, 4
    s_lshl_b32 s78, s74, 1
    s_add_u32 s77, s77, s78
    s_add_u32 s76, s76, s77
    s_lshl_b32 s76, s76, 10
    s_add_u32 s76, s76, 9437184
    s_cmp_lt_u32 s77, 86
    s_cselect_b32 s86, s76, 2147418112
    s_lshl_b32 s75, s74, 7
    s_add_u32 s75, s75, 161472
    v_lshl_add_u32 v221, v41, 4, s75
    s_add_u32 s74, s60, 2
    s_cmp_ge_u32 s74, 3
    s_cselect_b32 s75, 3, 0
    s_sub_u32 s74, s74, s75
    s_cmp_ge_u32 s74, 3
    s_cselect_b32 s75, 3, 0
    s_sub_u32 s74, s74, s75
    s_lshl_b32 s75, s74, 6
    v_add_u32 v230, s75, v42
    s_lshr_b32 s76, s68, 5
    s_add_u32 s76, s76, s60
    s_mul_i32 s76, s76, 86
    s_lshr_b32 s77, s69, 4
    s_lshl_b32 s78, s74, 1
    s_add_u32 s77, s77, s78
    s_add_u32 s76, s76, s77
    s_lshl_b32 s76, s76, 10
    s_add_u32 s76, s76, 9437184
    s_cmp_lt_u32 s77, 86
    s_cselect_b32 s13, s76, 2147418112
    s_lshl_b32 s75, s74, 7
    s_add_u32 s75, s75, 161472
    v_lshl_add_u32 v222, v41, 4, s75
    v_add_u32 v235, 57344, v228
    v_add_u32 v236, 57344, v229
    v_add_u32 v237, 57344, v230
    v_add_u32 v238, 57344, v231
    v_add_u32 v239, 57344, v232
    v_add_u32 v240, 57344, v233
    v_add_u32 v241, 57344, v234
    v_and_b32 v40, 15, v0
    v_bfe_u32 v41, v0, 4, 1
    v_cmp_eq_u32 vcc, v40, v41
    v_mov_b32 v42, 0x3f803f80
    s_nop 0
    v_cndmask_b32 v224, 0, v42, vcc
    v_mov_b32 v225, v224
    v_mov_b32 v226, v224
    v_mov_b32 v227, v224
    s_lshl_b32 s74, s92, 12
    s_add_u32 s74, s74, 135680
    v_lshlrev_b32 v33, 2, v0
    v_xor_b32 v144, 0, v33
    v_add_u32 v144, s74, v144
    v_xor_b32 v145, 32, v33
    v_add_u32 v145, s74, v145
    v_xor_b32 v146, 64, v33
    v_add_u32 v146, s74, v146
    v_xor_b32 v147, 96, v33
    v_add_u32 v147, s74, v147
    v_xor_b32 v148, 128, v33
    v_add_u32 v148, s74, v148
    v_xor_b32 v149, 160, v33
    v_add_u32 v149, s74, v149
    v_xor_b32 v150, 192, v33
    v_add_u32 v150, s74, v150
    v_xor_b32 v151, 224, v33
    v_add_u32 v151, s74, v151
    v_and_b32 v33, 15, v0
    v_lshrrev_b32 v34, 4, v0
    v_and_b32 v35, 7, v33
    v_lshlrev_b32 v35, 1, v35
    v_xor_b32 v35, v35, v34
    v_lshlrev_b32 v35, 4, v35
    v_lshl_add_u32 v35, v33, 8, v35
    v_xor_b32 v152, 0, v35
    v_add_u32 v152, s74, v152
    v_xor_b32 v153, 64, v35
    v_add_u32 v153, s74, v153
    v_xor_b32 v154, 128, v35
    v_add_u32 v154, s74, v154
    v_xor_b32 v155, 192, v35
    v_add_u32 v155, s74, v155
    s_waitcnt vmcnt(2)
    v_lshlrev_b32 v160, 16, v160
    v_lshlrev_b32 v161, 16, v161
    v_lshlrev_b32 v162, 16, v162
    v_lshlrev_b32 v163, 16, v163
    v_lshlrev_b32 v164, 16, v164
    v_lshlrev_b32 v165, 16, v165
    v_lshlrev_b32 v166, 16, v166
    v_lshlrev_b32 v167, 16, v167
    v_mul_f32 v34, 0x3fb8aa00, v166
    v_mul_f32 v35, 0x36a407db, v166
    v_exp_f32 v34, v34
    s_nop 0
    v_fmac_f32 v34, v34, v35
    v_cvt_pk_bf16_f32 v34, v34, v34
    v_and_b32 v34, 0xffff0000, v34
    v_mul_f32 v14, v34, v160
    v_mul_f32 v15, v34, v161
    v_mul_f32 v14, 0x3fb8aa3b, v14
    v_mul_f32 v15, 0x3e22f983, v15
    v_mul_f32 v162, v34, v162
    v_mul_f32 v163, v34, v163
    v_pk_mul_f32 v[16:17], v[164:165], v[162:163] op_sel_hi:[0,1]
    v_pk_fma_f32 v[16:17], v[164:165], v[162:163], v[16:17] op_sel:[1,1,0] op_sel_hi:[1,0,1] neg_lo:[1,0,0]
    v_mul_f32 v38, v16, v16
    v_fmac_f32 v38, v17, v17
    s_nop 1
    v_max_f32_dpp v38, v38, v38 row_shr:1 row_mask:0xf bank_mask:0xf
    s_nop 1
    v_max_f32_dpp v38, v38, v38 row_shr:2 row_mask:0xf bank_mask:0xf
    s_nop 1
    v_max_f32_dpp v38, v38, v38 row_shr:4 row_mask:0xf bank_mask:0xf
    s_nop 1
    v_max_f32_dpp v38, v38, v38 row_shr:8 row_mask:0xf bank_mask:0xf
    s_nop 1
    v_max_f32_dpp v38, v38, v38 row_bcast:15 row_mask:0xa bank_mask:0xf
    s_nop 1
    v_max_f32_dpp v38, v38, v38 row_bcast:31 row_mask:0xc bank_mask:0xf
    s_nop 0
    v_readlane_b32 s74, v38, 63
    v_mov_b32 v38, 0x03aa2425
    s_nop 0
    v_max_f32 v38, s74, v38
    v_rsq_f32 v39, v38
    s_nop 0
    v_mul_f32 v38, v38, v39
    s_nop 0
    v_readfirstlane_b32 s95, v38
    v_mul_f32 v40, v16, v39
    v_mul_f32 v41, v17, v39
    v_mul_f32 v34, 0x3f800000, v14
    v_mul_f32 v35, 0x3f800000, v15
    v_exp_f32 v34, v34
    v_fract_f32 v35, v35
    v_cos_f32 v36, v35
    v_sin_f32 v37, v35
    v_mul_f32 v18, v34, v36
    v_mul_f32 v19, v34, v37
    v_mul_f32 v34, 0x41000000, v14
    v_mul_f32 v35, 0x41000000, v15
    v_exp_f32 v34, v34
    v_fract_f32 v35, v35
    v_cos_f32 v36, v35
    v_sin_f32 v37, v35
    v_mul_f32 v24, v34, v36
    v_mul_f32 v25, v34, v37
    v_mul_f32 v34, 0x43000000, v14
    v_mul_f32 v35, 0x43000000, v15
    v_exp_f32 v34, v34
    v_fract_f32 v35, v35
    v_cos_f32 v36, v35
    v_sin_f32 v37, v35
    v_mul_f32 v26, v34, v36
    v_mul_f32 v27, v34, v37
    v_pk_mul_f32 v[20:21], v[18:19], v[18:19] op_sel_hi:[0,1]
    v_pk_fma_f32 v[20:21], v[18:19], v[18:19], v[20:21] op_sel:[1,1,0] op_sel_hi:[1,0,1] neg_lo:[1,0,0]
    v_pk_mul_f32 v[22:23], v[20:21], v[20:21] op_sel_hi:[0,1]
    v_pk_fma_f32 v[22:23], v[20:21], v[20:21], v[22:23] op_sel:[1,1,0] op_sel_hi:[1,0,1] neg_lo:[1,0,0]
    v_mov_b32 v80, 0x00003c00
    v_cvt_pk_f16_f32 v81, v24, v25
    v_pk_mul_f32 v[28:29], v[24:25], v[24:25] op_sel_hi:[0,1]
    v_pk_fma_f32 v[28:29], v[24:25], v[24:25], v[28:29] op_sel:[1,1,0] op_sel_hi:[1,0,1] neg_lo:[1,0,0]
    v_cvt_pk_f16_f32 v82, v28, v29
    v_pk_mul_f32 v[30:31], v[28:29], v[24:25] op_sel_hi:[0,1]
    v_pk_fma_f32 v[30:31], v[28:29], v[24:25], v[30:31] op_sel:[1,1,0] op_sel_hi:[1,0,1] neg_lo:[1,0,0]
    v_cvt_pk_f16_f32 v83, v30, v31
    v_pk_mul_f32 v[28:29], v[30:31], v[24:25] op_sel_hi:[0,1]
    v_pk_fma_f32 v[28:29], v[30:31], v[24:25], v[28:29] op_sel:[1,1,0] op_sel_hi:[1,0,1] neg_lo:[1,0,0]
    v_cvt_pk_f16_f32 v84, v28, v29
    v_pk_mul_f32 v[30:31], v[28:29], v[24:25] op_sel_hi:[0,1]
    v_pk_fma_f32 v[30:31], v[28:29], v[24:25], v[30:31] op_sel:[1,1,0] op_sel_hi:[1,0,1] neg_lo:[1,0,0]
    v_cvt_pk_f16_f32 v85, v30, v31
    v_pk_mul_f32 v[28:29], v[30:31], v[24:25] op_sel_hi:[0,1]
    v_pk_fma_f32 v[28:29], v[30:31], v[24:25], v[28:29] op_sel:[1,1,0] op_sel_hi:[1,0,1] neg_lo:[1,0,0]
    v_cvt_pk_f16_f32 v86, v28, v29
    v_pk_mul_f32 v[30:31], v[28:29], v[24:25] op_sel_hi:[0,1]
    v_pk_fma_f32 v[30:31], v[28:29], v[24:25], v[30:31] op_sel:[1,1,0] op_sel_hi:[1,0,1] neg_lo:[1,0,0]
    v_cvt_pk_f16_f32 v87, v30, v31
    v_pk_mul_f32 v[28:29], v[30:31], v[24:25] op_sel_hi:[0,1]
    v_pk_fma_f32 v[28:29], v[30:31], v[24:25], v[28:29] op_sel:[1,1,0] op_sel_hi:[1,0,1] neg_lo:[1,0,0]
    v_cvt_pk_f16_f32 v88, v28, v29
    v_pk_mul_f32 v[30:31], v[28:29], v[24:25] op_sel_hi:[0,1]
    v_pk_fma_f32 v[30:31], v[28:29], v[24:25], v[30:31] op_sel:[1,1,0] op_sel_hi:[1,0,1] neg_lo:[1,0,0]
    v_cvt_pk_f16_f32 v89, v30, v31
    v_pk_mul_f32 v[28:29], v[30:31], v[24:25] op_sel_hi:[0,1]
    v_pk_fma_f32 v[28:29], v[30:31], v[24:25], v[28:29] op_sel:[1,1,0] op_sel_hi:[1,0,1] neg_lo:[1,0,0]
    v_cvt_pk_f16_f32 v90, v28, v29
    v_pk_mul_f32 v[30:31], v[28:29], v[24:25] op_sel_hi:[0,1]
    v_pk_fma_f32 v[30:31], v[28:29], v[24:25], v[30:31] op_sel:[1,1,0] op_sel_hi:[1,0,1] neg_lo:[1,0,0]
    v_cvt_pk_f16_f32 v91, v30, v31
    v_pk_mul_f32 v[28:29], v[30:31], v[24:25] op_sel_hi:[0,1]
    v_pk_fma_f32 v[28:29], v[30:31], v[24:25], v[28:29] op_sel:[1,1,0] op_sel_hi:[1,0,1] neg_lo:[1,0,0]
    v_cvt_pk_f16_f32 v92, v28, v29
    v_pk_mul_f32 v[30:31], v[28:29], v[24:25] op_sel_hi:[0,1]
    v_pk_fma_f32 v[30:31], v[28:29], v[24:25], v[30:31] op_sel:[1,1,0] op_sel_hi:[1,0,1] neg_lo:[1,0,0]
    v_cvt_pk_f16_f32 v93, v30, v31
    v_pk_mul_f32 v[28:29], v[30:31], v[24:25] op_sel_hi:[0,1]
    v_pk_fma_f32 v[28:29], v[30:31], v[24:25], v[28:29] op_sel:[1,1,0] op_sel_hi:[1,0,1] neg_lo:[1,0,0]
    v_cvt_pk_f16_f32 v94, v28, v29
    v_pk_mul_f32 v[30:31], v[28:29], v[24:25] op_sel_hi:[0,1]
    v_pk_fma_f32 v[30:31], v[28:29], v[24:25], v[30:31] op_sel:[1,1,0] op_sel_hi:[1,0,1] neg_lo:[1,0,0]
    v_cvt_pk_f16_f32 v95, v30, v31
    ds_write2st64_b32 v144, v80, v88 offset0:0 offset1:8
    ds_write2st64_b32 v145, v81, v89 offset0:1 offset1:9
    ds_write2st64_b32 v146, v82, v90 offset0:2 offset1:10
    ds_write2st64_b32 v147, v83, v91 offset0:3 offset1:11
    ds_write2st64_b32 v148, v84, v92 offset0:4 offset1:12
    ds_write2st64_b32 v149, v85, v93 offset0:5 offset1:13
    ds_write2st64_b32 v150, v86, v94 offset0:6 offset1:14
    ds_write2st64_b32 v151, v87, v95 offset0:7 offset1:15
    ds_read_b128 v[96:99], v152
    ds_read_b128 v[100:103], v153
    ds_read_b128 v[104:107], v154
    ds_read_b128 v[108:111], v155
    v_pk_mul_f32 v[42:43], v[40:41], v[26:27] op_sel_hi:[0,1]
    v_pk_fma_f32 v[42:43], v[40:41], v[26:27], v[42:43] op_sel:[1,1,0] op_sel_hi:[1,0,1] neg_lo:[1,0,0]
    v_pk_mul_f32 v[44:45], v[42:43], v[26:27] op_sel_hi:[0,1]
    v_pk_fma_f32 v[44:45], v[42:43], v[26:27], v[44:45] op_sel:[1,1,0] op_sel_hi:[1,0,1] neg_lo:[1,0,0]
    v_pk_mul_f32 v[46:47], v[44:45], v[26:27] op_sel_hi:[0,1]
    v_pk_fma_f32 v[46:47], v[44:45], v[26:27], v[46:47] op_sel:[1,1,0] op_sel_hi:[1,0,1] neg_lo:[1,0,0]
    v_pk_mul_f32 v[48:49], v[46:47], v[26:27] op_sel_hi:[0,1]
    v_pk_fma_f32 v[48:49], v[46:47], v[26:27], v[48:49] op_sel:[1,1,0] op_sel_hi:[1,0,1] neg_lo:[1,0,0]
    v_pk_mul_f32 v[50:51], v[48:49], v[26:27] op_sel_hi:[0,1]
    v_pk_fma_f32 v[50:51], v[48:49], v[26:27], v[50:51] op_sel:[1,1,0] op_sel_hi:[1,0,1] neg_lo:[1,0,0]
    v_pk_mul_f32 v[52:53], v[50:51], v[26:27] op_sel_hi:[0,1]
    v_pk_fma_f32 v[52:53], v[50:51], v[26:27], v[52:53] op_sel:[1,1,0] op_sel_hi:[1,0,1] neg_lo:[1,0,0]
    v_pk_mul_f32 v[54:55], v[52:53], v[26:27] op_sel_hi:[0,1]
    v_pk_fma_f32 v[54:55], v[52:53], v[26:27], v[54:55] op_sel:[1,1,0] op_sel_hi:[1,0,1] neg_lo:[1,0,0]
    v_pk_mul_f32 v[56:57], v[54:55], v[26:27] op_sel_hi:[0,1]
    v_pk_fma_f32 v[56:57], v[54:55], v[26:27], v[56:57] op_sel:[1,1,0] op_sel_hi:[1,0,1] neg_lo:[1,0,0]
    v_pk_mul_f32 v[58:59], v[56:57], v[26:27] op_sel_hi:[0,1]
    v_pk_fma_f32 v[58:59], v[56:57], v[26:27], v[58:59] op_sel:[1,1,0] op_sel_hi:[1,0,1] neg_lo:[1,0,0]
    v_pk_mul_f32 v[60:61], v[58:59], v[26:27] op_sel_hi:[0,1]
    v_pk_fma_f32 v[60:61], v[58:59], v[26:27], v[60:61] op_sel:[1,1,0] op_sel_hi:[1,0,1] neg_lo:[1,0,0]
    v_pk_mul_f32 v[62:63], v[60:61], v[26:27] op_sel_hi:[0,1]
    v_pk_fma_f32 v[62:63], v[60:61], v[26:27], v[62:63] op_sel:[1,1,0] op_sel_hi:[1,0,1] neg_lo:[1,0,0]
    v_pk_mul_f32 v[64:65], v[62:63], v[26:27] op_sel_hi:[0,1]
    v_pk_fma_f32 v[64:65], v[62:63], v[26:27], v[64:65] op_sel:[1,1,0] op_sel_hi:[1,0,1] neg_lo:[1,0,0]
    v_pk_mul_f32 v[66:67], v[64:65], v[26:27] op_sel_hi:[0,1]
    v_pk_fma_f32 v[66:67], v[64:65], v[26:27], v[66:67] op_sel:[1,1,0] op_sel_hi:[1,0,1] neg_lo:[1,0,0]
    v_pk_mul_f32 v[68:69], v[66:67], v[26:27] op_sel_hi:[0,1]
    v_pk_fma_f32 v[68:69], v[66:67], v[26:27], v[68:69] op_sel:[1,1,0] op_sel_hi:[1,0,1] neg_lo:[1,0,0]
    v_pk_mul_f32 v[70:71], v[68:69], v[26:27] op_sel_hi:[0,1]
    v_pk_fma_f32 v[70:71], v[68:69], v[26:27], v[70:71] op_sel:[1,1,0] op_sel_hi:[1,0,1] neg_lo:[1,0,0]
    v_pk_mul_f32 v[72:73], v[70:71], v[26:27] op_sel_hi:[0,1]
    v_pk_fma_f32 v[72:73], v[70:71], v[26:27], v[72:73] op_sel:[1,1,0] op_sel_hi:[1,0,1] neg_lo:[1,0,0]
    s_barrier
    v_cvt_pk_f16_f32 v80, v40, -v41
    v_pk_mul_f32 v[28:29], v[40:41], v[18:19] op_sel_hi:[0,1]
    v_pk_fma_f32 v[28:29], v[40:41], v[18:19], v[28:29] op_sel:[1,1,0] op_sel_hi:[1,0,1] neg_lo:[1,0,0]
    v_cvt_pk_f16_f32 v81, v28, -v29
    v_pk_mul_f32 v[30:31], v[28:29], v[18:19] op_sel_hi:[0,1]
    v_pk_fma_f32 v[30:31], v[28:29], v[18:19], v[30:31] op_sel:[1,1,0] op_sel_hi:[1,0,1] neg_lo:[1,0,0]
    v_cvt_pk_f16_f32 v82, v30, -v31
    v_pk_mul_f32 v[28:29], v[30:31], v[18:19] op_sel_hi:[0,1]
    v_pk_fma_f32 v[28:29], v[30:31], v[18:19], v[28:29] op_sel:[1,1,0] op_sel_hi:[1,0,1] neg_lo:[1,0,0]
    v_cvt_pk_f16_f32 v83, v28, -v29
    v_pk_mul_f32 v[30:31], v[28:29], v[18:19] op_sel_hi:[0,1]
    v_pk_fma_f32 v[30:31], v[28:29], v[18:19], v[30:31] op_sel:[1,1,0] op_sel_hi:[1,0,1] neg_lo:[1,0,0]
    v_cvt_pk_f16_f32 v84, v30, -v31
    v_pk_mul_f32 v[28:29], v[30:31], v[18:19] op_sel_hi:[0,1]
    v_pk_fma_f32 v[28:29], v[30:31], v[18:19], v[28:29] op_sel:[1,1,0] op_sel_hi:[1,0,1] neg_lo:[1,0,0]
    v_cvt_pk_f16_f32 v85, v28, -v29
    v_pk_mul_f32 v[30:31], v[28:29], v[18:19] op_sel_hi:[0,1]
    v_pk_fma_f32 v[30:31], v[28:29], v[18:19], v[30:31] op_sel:[1,1,0] op_sel_hi:[1,0,1] neg_lo:[1,0,0]
    v_cvt_pk_f16_f32 v86, v30, -v31
    v_pk_mul_f32 v[28:29], v[30:31], v[18:19] op_sel_hi:[0,1]
    v_pk_fma_f32 v[28:29], v[30:31], v[18:19], v[28:29] op_sel:[1,1,0] op_sel_hi:[1,0,1] neg_lo:[1,0,0]
    v_cvt_pk_f16_f32 v87, v28, -v29
    v_cvt_pk_f16_f32 v88, v42, -v43
    v_pk_mul_f32 v[28:29], v[42:43], v[18:19] op_sel_hi:[0,1]
    v_pk_fma_f32 v[28:29], v[42:43], v[18:19], v[28:29] op_sel:[1,1,0] op_sel_hi:[1,0,1] neg_lo:[1,0,0]
    v_cvt_pk_f16_f32 v89, v28, -v29
    v_pk_mul_f32 v[30:31], v[28:29], v[18:19] op_sel_hi:[0,1]
    v_pk_fma_f32 v[30:31], v[28:29], v[18:19], v[30:31] op_sel:[1,1,0] op_sel_hi:[1,0,1] neg_lo:[1,0,0]
    v_cvt_pk_f16_f32 v90, v30, -v31
    v_pk_mul_f32 v[28:29], v[30:31], v[18:19] op_sel_hi:[0,1]
    v_pk_fma_f32 v[28:29], v[30:31], v[18:19], v[28:29] op_sel:[1,1,0] op_sel_hi:[1,0,1] neg_lo:[1,0,0]
    v_cvt_pk_f16_f32 v91, v28, -v29
    v_pk_mul_f32 v[30:31], v[28:29], v[18:19] op_sel_hi:[0,1]
    v_pk_fma_f32 v[30:31], v[28:29], v[18:19], v[30:31] op_sel:[1,1,0] op_sel_hi:[1,0,1] neg_lo:[1,0,0]
    v_cvt_pk_f16_f32 v92, v30, -v31
    v_pk_mul_f32 v[28:29], v[30:31], v[18:19] op_sel_hi:[0,1]
    v_pk_fma_f32 v[28:29], v[30:31], v[18:19], v[28:29] op_sel:[1,1,0] op_sel_hi:[1,0,1] neg_lo:[1,0,0]
    v_cvt_pk_f16_f32 v93, v28, -v29
    v_pk_mul_f32 v[30:31], v[28:29], v[18:19] op_sel_hi:[0,1]
    v_pk_fma_f32 v[30:31], v[28:29], v[18:19], v[30:31] op_sel:[1,1,0] op_sel_hi:[1,0,1] neg_lo:[1,0,0]
    v_cvt_pk_f16_f32 v94, v30, -v31
    v_pk_mul_f32 v[28:29], v[30:31], v[18:19] op_sel_hi:[0,1]
    v_pk_fma_f32 v[28:29], v[30:31], v[18:19], v[28:29] op_sel:[1,1,0] op_sel_hi:[1,0,1] neg_lo:[1,0,0]
    v_cvt_pk_f16_f32 v95, v28, -v29
    ds_write2st64_b32 v144, v80, v88 offset0:0 offset1:8
    ds_write2st64_b32 v145, v81, v89 offset0:1 offset1:9
    ds_write2st64_b32 v146, v82, v90 offset0:2 offset1:10
    ds_write2st64_b32 v147, v83, v91 offset0:3 offset1:11
    ds_write2st64_b32 v148, v84, v92 offset0:4 offset1:12
    ds_write2st64_b32 v149, v85, v93 offset0:5 offset1:13
    ds_write2st64_b32 v150, v86, v94 offset0:6 offset1:14
    ds_write2st64_b32 v151, v87, v95 offset0:7 offset1:15
    ds_read_b128 v[112:115], v152
    ds_read_b128 v[116:119], v153
    ds_read_b128 v[120:123], v154
    ds_read_b128 v[124:127], v155
    v_cvt_pk_f16_f32 v80, v44, -v45
    v_pk_mul_f32 v[28:29], v[44:45], v[20:21] op_sel_hi:[0,1]
    v_pk_fma_f32 v[28:29], v[44:45], v[20:21], v[28:29] op_sel:[1,1,0] op_sel_hi:[1,0,1] neg_lo:[1,0,0]
    v_cvt_pk_f16_f32 v81, v28, -v29
    v_pk_mul_f32 v[30:31], v[28:29], v[20:21] op_sel_hi:[0,1]
    v_pk_fma_f32 v[30:31], v[28:29], v[20:21], v[30:31] op_sel:[1,1,0] op_sel_hi:[1,0,1] neg_lo:[1,0,0]
    v_cvt_pk_f16_f32 v82, v30, -v31
    v_pk_mul_f32 v[28:29], v[30:31], v[20:21] op_sel_hi:[0,1]
    v_pk_fma_f32 v[28:29], v[30:31], v[20:21], v[28:29] op_sel:[1,1,0] op_sel_hi:[1,0,1] neg_lo:[1,0,0]
    v_cvt_pk_f16_f32 v83, v28, -v29
    v_cvt_pk_f16_f32 v84, v46, -v47
    v_pk_mul_f32 v[28:29], v[46:47], v[20:21] op_sel_hi:[0,1]
    v_pk_fma_f32 v[28:29], v[46:47], v[20:21], v[28:29] op_sel:[1,1,0] op_sel_hi:[1,0,1] neg_lo:[1,0,0]
    v_cvt_pk_f16_f32 v85, v28, -v29
    v_pk_mul_f32 v[30:31], v[28:29], v[20:21] op_sel_hi:[0,1]
    v_pk_fma_f32 v[30:31], v[28:29], v[20:21], v[30:31] op_sel:[1,1,0] op_sel_hi:[1,0,1] neg_lo:[1,0,0]
    v_cvt_pk_f16_f32 v86, v30, -v31
    v_pk_mul_f32 v[28:29], v[30:31], v[20:21] op_sel_hi:[0,1]
    v_pk_fma_f32 v[28:29], v[30:31], v[20:21], v[28:29] op_sel:[1,1,0] op_sel_hi:[1,0,1] neg_lo:[1,0,0]
    v_cvt_pk_f16_f32 v87, v28, -v29
    v_cvt_pk_f16_f32 v88, v48, -v49
    v_pk_mul_f32 v[28:29], v[48:49], v[22:23] op_sel_hi:[0,1]
    v_pk_fma_f32 v[28:29], v[48:49], v[22:23], v[28:29] op_sel:[1,1,0] op_sel_hi:[1,0,1] neg_lo:[1,0,0]
    v_cvt_pk_f16_f32 v89, v28, -v29
    v_cvt_pk_f16_f32 v90, v50, -v51
    v_pk_mul_f32 v[28:29], v[50:51], v[22:23] op_sel_hi:[0,1]
    v_pk_fma_f32 v[28:29], v[50:51], v[22:23], v[28:29] op_sel:[1,1,0] op_sel_hi:[1,0,1] neg_lo:[1,0,0]
    v_cvt_pk_f16_f32 v91, v28, -v29
    v_cvt_pk_f16_f32 v92, v52, -v53
    v_pk_mul_f32 v[28:29], v[52:53], v[22:23] op_sel_hi:[0,1]
    v_pk_fma_f32 v[28:29], v[52:53], v[22:23], v[28:29] op_sel:[1,1,0] op_sel_hi:[1,0,1] neg_lo:[1,0,0]
    v_cvt_pk_f16_f32 v93, v28, -v29
    v_cvt_pk_f16_f32 v94, v54, -v55
    v_pk_mul_f32 v[28:29], v[54:55], v[22:23] op_sel_hi:[0,1]
    v_pk_fma_f32 v[28:29], v[54:55], v[22:23], v[28:29] op_sel:[1,1,0] op_sel_hi:[1,0,1] neg_lo:[1,0,0]
    v_cvt_pk_f16_f32 v95, v28, -v29
    s_waitcnt lgkmcnt(12)
    s_waitcnt lgkmcnt(0)
    v_mfma_f32_16x16x32_f16 v[128:131], v[112:115], v[96:99], 0
    v_mfma_f32_16x16x32_f16 v[128:131], v[116:119], v[100:103], v[128:131]
    v_mfma_f32_16x16x32_f16 v[128:131], v[120:123], v[104:107], v[128:131]
    v_mfma_f32_16x16x32_f16 v[128:131], v[124:127], v[108:111], v[128:131]
    ds_write2st64_b32 v144, v80, v88 offset0:0 offset1:8
    ds_write2st64_b32 v145, v81, v89 offset0:1 offset1:9
    ds_write2st64_b32 v146, v82, v90 offset0:2 offset1:10
    ds_write2st64_b32 v147, v83, v91 offset0:3 offset1:11
    ds_write2st64_b32 v148, v84, v92 offset0:4 offset1:12
    ds_write2st64_b32 v149, v85, v93 offset0:5 offset1:13
    ds_write2st64_b32 v150, v86, v94 offset0:6 offset1:14
    ds_write2st64_b32 v151, v87, v95 offset0:7 offset1:15
    ds_read_b128 v[112:115], v152
    ds_read_b128 v[116:119], v153
    ds_read_b128 v[120:123], v154
    ds_read_b128 v[124:127], v155
    v_cvt_pk_f16_f32 v80, v56, -v57
    v_cvt_pk_f16_f32 v81, v58, -v59
    v_cvt_pk_f16_f32 v82, v60, -v61
    v_cvt_pk_f16_f32 v83, v62, -v63
    v_cvt_pk_f16_f32 v84, v64, -v65
    v_cvt_pk_f16_f32 v85, v66, -v67
    v_cvt_pk_f16_f32 v86, v68, -v69
    v_cvt_pk_f16_f32 v87, v70, -v71
    v_cvt_pk_f16_f32 v88, v72, -v73
    v_mov_b32 v89, 0
    v_mov_b32 v90, 0
    v_mov_b32 v91, 0
    v_mov_b32 v92, 0
    v_mov_b32 v93, 0
    v_mov_b32 v94, 0
    v_mov_b32 v95, 0
    s_waitcnt lgkmcnt(0)
    v_mfma_f32_16x16x32_f16 v[132:135], v[112:115], v[96:99], 0
    v_mfma_f32_16x16x32_f16 v[132:135], v[116:119], v[100:103], v[132:135]
    v_mfma_f32_16x16x32_f16 v[132:135], v[120:123], v[104:107], v[132:135]
    v_mfma_f32_16x16x32_f16 v[132:135], v[124:127], v[108:111], v[132:135]
    ds_write2st64_b32 v144, v80, v88 offset0:0 offset1:8
    ds_write2st64_b32 v145, v81, v89 offset0:1 offset1:9
    ds_write2st64_b32 v146, v82, v90 offset0:2 offset1:10
    ds_write2st64_b32 v147, v83, v91 offset0:3 offset1:11
    ds_write2st64_b32 v148, v84, v92 offset0:4 offset1:12
    ds_write2st64_b32 v149, v85, v93 offset0:5 offset1:13
    ds_write2st64_b32 v150, v86, v94 offset0:6 offset1:14
    ds_write2st64_b32 v151, v87, v95 offset0:7 offset1:15
    ds_read_b128 v[112:115], v152
    ds_read_b128 v[116:119], v153
    ds_read_b128 v[120:123], v154
    ds_read_b128 v[124:127], v155
    s_waitcnt lgkmcnt(0)
    v_mfma_f32_16x16x32_f16 v[136:139], v[112:115], v[96:99], 0
    v_mfma_f32_16x16x32_f16 v[136:139], v[116:119], v[100:103], v[136:139]
    v_mfma_f32_16x16x32_f16 v[136:139], v[120:123], v[104:107], v[136:139]
    v_mfma_f32_16x16x32_f16 v[136:139], v[124:127], v[108:111], v[136:139]
    s_lshl_b32 s74, s92, 12
    s_add_u32 s74, s74, 135680
    v_add_u32 v33, s74, v2
    v_mov_b32 v34, s95
    v_mov_b32 v35, s74
    ds_write_b128 v33, v[128:131] offset:0
    ds_write_b128 v33, v[132:135] offset:1024
    s_nop 0
    ds_write_b128 v33, v[136:139] offset:2048
    ds_write_b32 v35, v34 offset:3072
    s_waitcnt lgkmcnt(0)
    s_barrier
    s_cmp_eq_u32 s70, 0
    s_cbranch_scc1 L_idleC
    ds_read_b128 v[132:135], v231 offset:0
    ds_read_b64_tr_b16 v[120:121], v228 offset:0
    ds_read_b64_tr_b16 v[122:123], v228 offset:768
    ds_read_b64_tr_b16 v[124:125], v229 offset:0
    ds_read_b64_tr_b16 v[126:127], v229 offset:768
    ds_read_b64_tr_b16 v[128:129], v230 offset:0
    ds_read_b64_tr_b16 v[130:131], v230 offset:768
    ds_read_b128 v[148:151], v232 offset:0
    ds_read_b64_tr_b16 v[136:137], v228 offset:3072
    ds_read_b64_tr_b16 v[138:139], v228 offset:3840
    ds_read_b64_tr_b16 v[140:141], v229 offset:3072
    ds_read_b64_tr_b16 v[142:143], v229 offset:3840
    ds_read_b64_tr_b16 v[144:145], v230 offset:3072
    ds_read_b64_tr_b16 v[146:147], v230 offset:3840
    s_waitcnt lgkmcnt(7)
    v_mfma_f32_32x32x16_bf16 v[64:79], v[120:123], v[132:135], 0
    ds_read_b128 v[164:167], v233 offset:0
    ds_read_b64_tr_b16 v[152:153], v228 offset:6144
    v_mfma_f32_16x16x32_bf16 v[112:115], v[120:123], v[224:227], 0
    ds_read_b64_tr_b16 v[154:155], v228 offset:6912
    ds_read_b64_tr_b16 v[156:157], v229 offset:6144
    v_mfma_f32_32x32x16_bf16 v[80:95], v[124:127], v[132:135], 0
    ds_read_b64_tr_b16 v[158:159], v229 offset:6912
    ds_read_b64_tr_b16 v[160:161], v230 offset:6144
    v_mfma_f32_32x32x16_bf16 v[96:111], v[128:131], v[132:135], 0
    ds_read_b64_tr_b16 v[162:163], v230 offset:6912
    s_waitcnt lgkmcnt(7)
    v_mfma_f32_32x32x16_bf16 v[64:79], v[136:139], v[148:151], v[64:79]
    ds_read_b128 v[132:135], v234 offset:0
    ds_read_b64_tr_b16 v[120:121], v228 offset:9216
    ds_read_b64_tr_b16 v[122:123], v228 offset:9984
    v_mfma_f32_16x16x32_bf16 v[112:115], v[136:139], v[224:227], v[112:115]
    ds_read_b64_tr_b16 v[124:125], v229 offset:9216
    ds_read_b64_tr_b16 v[126:127], v229 offset:9984
    ds_read_b64_tr_b16 v[128:129], v230 offset:9216
    v_mfma_f32_32x32x16_bf16 v[80:95], v[140:143], v[148:151], v[80:95]
    ds_read_b64_tr_b16 v[130:131], v230 offset:9984
    s_lshr_b32 s74, s60, 1
    v_mfma_f32_32x32x16_bf16 v[96:111], v[144:147], v[148:151], v[96:111]
    v_and_b32 v4, 15, v0
    v_lshrrev_b32 v5, 4, v0
    s_barrier
    s_waitcnt lgkmcnt(7)
    v_mfma_f32_32x32x16_bf16 v[64:79], v[152:155], v[164:167], v[64:79]
    ds_read_b128 v[148:151], v231 offset:28672
    ds_read_b64_tr_b16 v[136:137], v228 offset:28672
    ds_read_b64_tr_b16 v[138:139], v228 offset:29440
    v_mfma_f32_16x16x32_bf16 v[112:115], v[152:155], v[224:227], v[112:115]
    ds_read_b64_tr_b16 v[140:141], v229 offset:28672
    ds_read_b64_tr_b16 v[142:143], v229 offset:29440
    ds_read_b64_tr_b16 v[144:145], v230 offset:28672
    v_mfma_f32_32x32x16_bf16 v[80:95], v[156:159], v[164:167], v[80:95]
    ds_read_b64_tr_b16 v[146:147], v230 offset:29440
    s_mul_i32 s75, s74, 4672
    v_mfma_f32_32x32x16_bf16 v[96:111], v[160:163], v[164:167], v[96:111]
    s_add_u32 s75, s75, 152080
    v_lshlrev_b32 v6, 5, v4
    s_waitcnt lgkmcnt(7)
    v_mfma_f32_32x32x16_bf16 v[64:79], v[120:123], v[132:135], v[64:79]
    ds_read_b128 v[164:167], v232 offset:28672
    ds_read_b64_tr_b16 v[152:153], v228 offset:31744
    ds_read_b64_tr_b16 v[154:155], v228 offset:32512
    v_mfma_f32_16x16x32_bf16 v[112:115], v[120:123], v[224:227], v[112:115]
    ds_read_b64_tr_b16 v[156:157], v229 offset:31744
    ds_read_b64_tr_b16 v[158:159], v229 offset:32512
    ds_read_b64_tr_b16 v[160:161], v230 offset:31744
    v_mfma_f32_32x32x16_bf16 v[80:95], v[124:127], v[132:135], v[80:95]
    ds_read_b64_tr_b16 v[162:163], v230 offset:32512
    v_lshl_add_u32 v6, v5, 4, v6
    v_mfma_f32_32x32x16_bf16 v[96:111], v[128:131], v[132:135], v[96:111]
    v_add_u32 v8, s75, v6
    v_sub_u32 v6, 3, v4
    s_waitcnt lgkmcnt(7)
    v_mfma_f32_32x32x16_bf16 v[64:79], v[136:139], v[148:151], v[64:79]
    ds_read_b128 v[132:135], v233 offset:28672
    ds_read_b64_tr_b16 v[120:121], v228 offset:34816
    ds_read_b64_tr_b16 v[122:123], v228 offset:35584
    v_mfma_f32_16x16x32_bf16 v[112:115], v[136:139], v[224:227], v[112:115]
    ds_read_b64_tr_b16 v[124:125], v229 offset:34816
    ds_read_b64_tr_b16 v[126:127], v229 offset:35584
    ds_read_b64_tr_b16 v[128:129], v230 offset:34816
    v_mfma_f32_32x32x16_bf16 v[80:95], v[140:143], v[148:151], v[80:95]
    ds_read_b64_tr_b16 v[130:131], v230 offset:35584
    v_and_b32 v6, 3, v6
    v_mfma_f32_32x32x16_bf16 v[96:111], v[144:147], v[148:151], v[96:111]
    s_mul_i32 s75, s74, 10496
    s_add_u32 s75, s75, 114688
    s_waitcnt lgkmcnt(7)
    v_mfma_f32_32x32x16_bf16 v[64:79], v[152:155], v[164:167], v[64:79]
    ds_read_b128 v[148:151], v234 offset:28672
    ds_read_b64_tr_b16 v[136:137], v228 offset:37888
    ds_read_b64_tr_b16 v[138:139], v228 offset:38656
    v_mfma_f32_16x16x32_bf16 v[112:115], v[152:155], v[224:227], v[112:115]
    ds_read_b64_tr_b16 v[140:141], v229 offset:37888
    ds_read_b64_tr_b16 v[142:143], v229 offset:38656
    ds_read_b64_tr_b16 v[144:145], v230 offset:37888
    v_mfma_f32_32x32x16_bf16 v[80:95], v[156:159], v[164:167], v[80:95]
    ds_read_b64_tr_b16 v[146:147], v230 offset:38656
    v_mul_u32_u24 v7, 2624, v6
    v_mfma_f32_32x32x16_bf16 v[96:111], v[160:163], v[164:167], v[96:111]
    v_add_u32 v7, s75, v7
    v_add_u32 v6, v6, v4
    s_barrier
    s_waitcnt lgkmcnt(7)
    v_mfma_f32_32x32x16_bf16 v[64:79], v[120:123], v[132:135], v[64:79]
    ds_read_b128 v[164:167], v238 offset:0
    ds_read_b64_tr_b16 v[152:153], v235 offset:0
    ds_read_b64_tr_b16 v[154:155], v235 offset:768
    v_mfma_f32_16x16x32_bf16 v[112:115], v[120:123], v[224:227], v[112:115]
    ds_read_b64_tr_b16 v[156:157], v236 offset:0
    ds_read_b64_tr_b16 v[158:159], v236 offset:768
    ds_read_b64_tr_b16 v[160:161], v237 offset:0
    v_mfma_f32_32x32x16_bf16 v[80:95], v[124:127], v[132:135], v[80:95]
    ds_read_b64_tr_b16 v[162:163], v237 offset:768
    v_lshlrev_b32 v12, 3, v5
    v_mfma_f32_32x32x16_bf16 v[96:111], v[128:131], v[132:135], v[96:111]
    v_sub_u32 v12, v12, v6
    v_add_u32 v12, 27, v12
    s_waitcnt lgkmcnt(7)
    v_mfma_f32_32x32x16_bf16 v[64:79], v[136:139], v[148:151], v[64:79]
    ds_read_b128 v[132:135], v239 offset:0
    ds_read_b64_tr_b16 v[120:121], v235 offset:3072
    ds_read_b64_tr_b16 v[122:123], v235 offset:3840
    v_mfma_f32_16x16x32_bf16 v[112:115], v[136:139], v[224:227], v[112:115]
    ds_read_b64_tr_b16 v[124:125], v236 offset:3072
    ds_read_b64_tr_b16 v[126:127], v236 offset:3840
    ds_read_b64_tr_b16 v[128:129], v237 offset:3072
    v_mfma_f32_32x32x16_bf16 v[80:95], v[140:143], v[148:151], v[80:95]
    ds_read_b64_tr_b16 v[130:131], v237 offset:3840
    v_lshl_add_u32 v9, v12, 1, v7
    v_mfma_f32_32x32x16_bf16 v[96:111], v[144:147], v[148:151], v[96:111]
    v_lshlrev_b32 v12, 2, v5
    v_sub_u32 v12, v12, v6
    s_waitcnt lgkmcnt(7)
    v_mfma_f32_32x32x16_bf16 v[64:79], v[152:155], v[164:167], v[64:79]
    ds_read_b128 v[148:151], v240 offset:0
    ds_read_b64_tr_b16 v[136:137], v235 offset:6144
    ds_read_b64_tr_b16 v[138:139], v235 offset:6912
    v_mfma_f32_16x16x32_bf16 v[112:115], v[152:155], v[224:227], v[112:115]
    ds_read_b64_tr_b16 v[140:141], v236 offset:6144
    ds_read_b64_tr_b16 v[142:143], v236 offset:6912
    ds_read_b64_tr_b16 v[144:145], v237 offset:6144
    v_mfma_f32_32x32x16_bf16 v[80:95], v[156:159], v[164:167], v[80:95]
    ds_read_b64_tr_b16 v[146:147], v237 offset:6912
    v_add_u32 v12, 19, v12
    v_mfma_f32_32x32x16_bf16 v[96:111], v[160:163], v[164:167], v[96:111]
    v_lshl_add_u32 v10, v12, 1, v7
    s_lshl_b32 s75, s74, 2
    s_waitcnt lgkmcnt(7)
    v_mfma_f32_32x32x16_bf16 v[64:79], v[120:123], v[132:135], v[64:79]
    ds_read_b128 v[164:167], v241 offset:0
    ds_read_b64_tr_b16 v[152:153], v235 offset:9216
    ds_read_b64_tr_b16 v[154:155], v235 offset:9984
    v_mfma_f32_16x16x32_bf16 v[112:115], v[120:123], v[224:227], v[112:115]
    ds_read_b64_tr_b16 v[156:157], v236 offset:9216
    ds_read_b64_tr_b16 v[158:159], v236 offset:9984
    v_mfma_f32_32x32x16_bf16 v[80:95], v[124:127], v[132:135], v[80:95]
    ds_read_b64_tr_b16 v[160:161], v237 offset:9216
    ds_read_b64_tr_b16 v[162:163], v237 offset:9984
    v_mfma_f32_32x32x16_bf16 v[96:111], v[128:131], v[132:135], v[96:111]
    s_add_u32 s75, s75, 161408
    v_mov_b32 v11, s75
    s_barrier
    s_waitcnt lgkmcnt(7)
    v_mfma_f32_32x32x16_bf16 v[64:79], v[136:139], v[148:151], v[64:79]
    ds_read_b128 v[132:135], v238 offset:28672
    ds_read_b64_tr_b16 v[120:121], v235 offset:28672
    ds_read_b64_tr_b16 v[122:123], v235 offset:29440
    v_mfma_f32_16x16x32_bf16 v[112:115], v[136:139], v[224:227], v[112:115]
    ds_read_b64_tr_b16 v[124:125], v236 offset:28672
    ds_read_b64_tr_b16 v[126:127], v236 offset:29440
    v_mfma_f32_32x32x16_bf16 v[80:95], v[140:143], v[148:151], v[80:95]
    ds_read_b64_tr_b16 v[128:129], v237 offset:28672
    ds_read_b64_tr_b16 v[130:131], v237 offset:29440
    v_mfma_f32_32x32x16_bf16 v[96:111], v[144:147], v[148:151], v[96:111]
    v_add_u32 v6, 4, v4
    v_mov_b32 v7, 511
    s_waitcnt lgkmcnt(7)
    v_mfma_f32_32x32x16_bf16 v[64:79], v[152:155], v[164:167], v[64:79]
    ds_read_b128 v[148:151], v239 offset:28672
    ds_read_b64_tr_b16 v[136:137], v235 offset:31744
    ds_read_b64_tr_b16 v[138:139], v235 offset:32512
    v_mfma_f32_16x16x32_bf16 v[112:115], v[152:155], v[224:227], v[112:115]
    ds_read_b64_tr_b16 v[140:141], v236 offset:31744
    ds_read_b64_tr_b16 v[142:143], v236 offset:32512
    v_mfma_f32_32x32x16_bf16 v[80:95], v[156:159], v[164:167], v[80:95]
    ds_read_b64_tr_b16 v[144:145], v237 offset:31744
    ds_read_b64_tr_b16 v[146:147], v237 offset:32512
    v_mfma_f32_32x32x16_bf16 v[96:111], v[160:163], v[164:167], v[96:111]
    v_lshlrev_b32 v7, v6, v7
    v_lshlrev_b32 v6, 3, v5
    s_waitcnt lgkmcnt(7)
    v_mfma_f32_32x32x16_bf16 v[64:79], v[120:123], v[132:135], v[64:79]
    ds_read_b128 v[164:167], v240 offset:28672
    ds_read_b64_tr_b16 v[152:153], v235 offset:34816
    ds_read_b64_tr_b16 v[154:155], v235 offset:35584
    v_mfma_f32_16x16x32_bf16 v[112:115], v[120:123], v[224:227], v[112:115]
    ds_read_b64_tr_b16 v[156:157], v236 offset:34816
    ds_read_b64_tr_b16 v[158:159], v236 offset:35584
    v_mfma_f32_32x32x16_bf16 v[80:95], v[124:127], v[132:135], v[80:95]
    ds_read_b64_tr_b16 v[160:161], v237 offset:34816
    ds_read_b64_tr_b16 v[162:163], v237 offset:35584
    v_mfma_f32_32x32x16_bf16 v[96:111], v[128:131], v[132:135], v[96:111]
    v_lshrrev_b32 v7, v6, v7
    v_bfe_u32 v6, v7, 0, 1
    s_waitcnt lgkmcnt(7)
    v_mfma_f32_32x32x16_bf16 v[64:79], v[136:139], v[148:151], v[64:79]
    ds_read_b128 v[132:135], v241 offset:28672
    ds_read_b64_tr_b16 v[120:121], v235 offset:37888
    ds_read_b64_tr_b16 v[122:123], v235 offset:38656
    v_mfma_f32_16x16x32_bf16 v[112:115], v[136:139], v[224:227], v[112:115]
    ds_read_b64_tr_b16 v[124:125], v236 offset:37888
    ds_read_b64_tr_b16 v[126:127], v236 offset:38656
    v_mfma_f32_32x32x16_bf16 v[80:95], v[140:143], v[148:151], v[80:95]
    ds_read_b64_tr_b16 v[128:129], v237 offset:37888
    ds_read_b64_tr_b16 v[130:131], v237 offset:38656
    v_mfma_f32_32x32x16_bf16 v[96:111], v[144:147], v[148:151], v[96:111]
    v_bfe_u32 v12, v7, 1, 1
    v_lshl_or_b32 v6, v12, 16, v6
    s_barrier
    s_waitcnt lgkmcnt(7)
    v_mfma_f32_32x32x16_bf16 v[64:79], v[152:155], v[164:167], v[64:79]
    ds_read_b128 v[148:151], v231 offset:0
    ds_read_b64_tr_b16 v[136:137], v228 offset:0
    ds_read_b64_tr_b16 v[138:139], v228 offset:768
    v_mfma_f32_16x16x32_bf16 v[112:115], v[152:155], v[224:227], v[112:115]
    ds_read_b64_tr_b16 v[140:141], v229 offset:0
    ds_read_b64_tr_b16 v[142:143], v229 offset:768
    v_mfma_f32_32x32x16_bf16 v[80:95], v[156:159], v[164:167], v[80:95]
    ds_read_b64_tr_b16 v[144:145], v230 offset:0
    ds_read_b64_tr_b16 v[146:147], v230 offset:768
    v_mfma_f32_32x32x16_bf16 v[96:111], v[160:163], v[164:167], v[96:111]
    v_mul_u32_u24 v56, 0x3c00, v6
    v_bfe_u32 v6, v7, 2, 1
    s_waitcnt lgkmcnt(7)
    v_mfma_f32_32x32x16_bf16 v[64:79], v[120:123], v[132:135], v[64:79]
    ds_read_b128 v[164:167], v232 offset:0
    ds_read_b64_tr_b16 v[152:153], v228 offset:3072
    ds_read_b64_tr_b16 v[154:155], v228 offset:3840
    v_mfma_f32_16x16x32_bf16 v[112:115], v[120:123], v[224:227], v[112:115]
    ds_read_b64_tr_b16 v[156:157], v229 offset:3072
    ds_read_b64_tr_b16 v[158:159], v229 offset:3840
    v_mfma_f32_32x32x16_bf16 v[80:95], v[124:127], v[132:135], v[80:95]
    ds_read_b64_tr_b16 v[160:161], v230 offset:3072
    ds_read_b64_tr_b16 v[162:163], v230 offset:3840
    v_mfma_f32_32x32x16_bf16 v[96:111], v[128:131], v[132:135], v[96:111]
    v_bfe_u32 v12, v7, 3, 1
    v_lshl_or_b32 v6, v12, 16, v6
    s_waitcnt lgkmcnt(7)
    v_mfma_f32_32x32x16_bf16 v[64:79], v[136:139], v[148:151], v[64:79]
    ds_read_b128 v[132:135], v233 offset:0
    ds_read_b64_tr_b16 v[120:121], v228 offset:6144
    ds_read_b64_tr_b16 v[122:123], v228 offset:6912
    v_mfma_f32_16x16x32_bf16 v[112:115], v[136:139], v[224:227], v[112:115]
    ds_read_b64_tr_b16 v[124:125], v229 offset:6144
    ds_read_b64_tr_b16 v[126:127], v229 offset:6912
    v_mfma_f32_32x32x16_bf16 v[80:95], v[140:143], v[148:151], v[80:95]
    ds_read_b64_tr_b16 v[128:129], v230 offset:6144
    ds_read_b64_tr_b16 v[130:131], v230 offset:6912
    v_mfma_f32_32x32x16_bf16 v[96:111], v[144:147], v[148:151], v[96:111]
    v_mul_u32_u24 v57, 0x3c00, v6
    v_bfe_u32 v6, v7, 4, 1
    s_waitcnt lgkmcnt(7)
    v_mfma_f32_32x32x16_bf16 v[64:79], v[152:155], v[164:167], v[64:79]
    ds_read_b128 v[148:151], v234 offset:0
    ds_read_b64_tr_b16 v[136:137], v228 offset:9216
    ds_read_b64_tr_b16 v[138:139], v228 offset:9984
    v_mfma_f32_16x16x32_bf16 v[112:115], v[152:155], v[224:227], v[112:115]
    ds_read_b64_tr_b16 v[140:141], v229 offset:9216
    ds_read_b64_tr_b16 v[142:143], v229 offset:9984
    v_mfma_f32_32x32x16_bf16 v[80:95], v[156:159], v[164:167], v[80:95]
    ds_read_b64_tr_b16 v[144:145], v230 offset:9216
    ds_read_b64_tr_b16 v[146:147], v230 offset:9984
    v_mfma_f32_32x32x16_bf16 v[96:111], v[160:163], v[164:167], v[96:111]
    v_bfe_u32 v12, v7, 5, 1
    v_lshl_or_b32 v6, v12, 16, v6
    s_barrier
    s_waitcnt lgkmcnt(7)
    v_mfma_f32_32x32x16_bf16 v[64:79], v[120:123], v[132:135], v[64:79]
    ds_read_b128 v[164:167], v231 offset:28672
    ds_read_b64_tr_b16 v[152:153], v228 offset:28672
    ds_read_b64_tr_b16 v[154:155], v228 offset:29440
    v_mfma_f32_16x16x32_bf16 v[112:115], v[120:123], v[224:227], v[112:115]
    ds_read_b64_tr_b16 v[156:157], v229 offset:28672
    ds_read_b64_tr_b16 v[158:159], v229 offset:29440
    v_mfma_f32_32x32x16_bf16 v[80:95], v[124:127], v[132:135], v[80:95]
    ds_read_b64_tr_b16 v[160:161], v230 offset:28672
    ds_read_b64_tr_b16 v[162:163], v230 offset:29440
    v_mfma_f32_32x32x16_bf16 v[96:111], v[128:131], v[132:135], v[96:111]
    v_mul_u32_u24 v58, 0x3c00, v6
    v_bfe_u32 v6, v7, 6, 1
    s_waitcnt lgkmcnt(7)
    v_mfma_f32_32x32x16_bf16 v[64:79], v[136:139], v[148:151], v[64:79]
    ds_read_b128 v[132:135], v232 offset:28672
    ds_read_b64_tr_b16 v[120:121], v228 offset:31744
    ds_read_b64_tr_b16 v[122:123], v228 offset:32512
    v_mfma_f32_16x16x32_bf16 v[112:115], v[136:139], v[224:227], v[112:115]
    ds_read_b64_tr_b16 v[124:125], v229 offset:31744
    ds_read_b64_tr_b16 v[126:127], v229 offset:32512
    v_mfma_f32_32x32x16_bf16 v[80:95], v[140:143], v[148:151], v[80:95]
    ds_read_b64_tr_b16 v[128:129], v230 offset:31744
    ds_read_b64_tr_b16 v[130:131], v230 offset:32512
    v_mfma_f32_32x32x16_bf16 v[96:111], v[144:147], v[148:151], v[96:111]
    v_bfe_u32 v12, v7, 7, 1
    v_lshl_or_b32 v6, v12, 16, v6
    s_waitcnt lgkmcnt(7)
    v_mfma_f32_32x32x16_bf16 v[64:79], v[152:155], v[164:167], v[64:79]
    ds_read_b128 v[148:151], v233 offset:28672
    ds_read_b64_tr_b16 v[136:137], v228 offset:34816
    ds_read_b64_tr_b16 v[138:139], v228 offset:35584
    v_mfma_f32_16x16x32_bf16 v[112:115], v[152:155], v[224:227], v[112:115]
    ds_read_b64_tr_b16 v[140:141], v229 offset:34816
    ds_read_b64_tr_b16 v[142:143], v229 offset:35584
    ds_read_b64_tr_b16 v[144:145], v230 offset:34816
    v_mfma_f32_32x32x16_bf16 v[80:95], v[156:159], v[164:167], v[80:95]
    ds_read_b64_tr_b16 v[146:147], v230 offset:35584
    v_mul_u32_u24 v59, 0x3c00, v6
    v_mfma_f32_32x32x16_bf16 v[96:111], v[160:163], v[164:167], v[96:111]
    v_add_u32 v6, 5, v4
    s_lshl_b32 s78, s60, 5
    s_add_u32 s78, s78, s68
    s_lshl_b32 s78, s78, 4
    s_add_u32 s78, s78, 4096
    v_and_b32 v47, 31, v0
    v_lshlrev_b32 v47, 4, v47
    buffer_load_dwordx4 v[216:219], v47, s[52:55], s78 offen sc1
    s_waitcnt lgkmcnt(7)
    v_mfma_f32_32x32x16_bf16 v[64:79], v[120:123], v[132:135], v[64:79]
    ds_read_b128 v[164:167], v234 offset:28672
    ds_read_b64_tr_b16 v[152:153], v228 offset:37888
    ds_read_b64_tr_b16 v[154:155], v228 offset:38656
    v_mfma_f32_16x16x32_bf16 v[112:115], v[120:123], v[224:227], v[112:115]
    ds_read_b64_tr_b16 v[156:157], v229 offset:37888
    ds_read_b64_tr_b16 v[158:159], v229 offset:38656
    v_mfma_f32_32x32x16_bf16 v[80:95], v[124:127], v[132:135], v[80:95]
    ds_read_b64_tr_b16 v[160:161], v230 offset:37888
    ds_read_b64_tr_b16 v[162:163], v230 offset:38656
    v_mfma_f32_32x32x16_bf16 v[96:111], v[128:131], v[132:135], v[96:111]
    v_mov_b32 v7, 127
    v_lshlrev_b32 v7, v6, v7
    s_barrier
    s_waitcnt lgkmcnt(7)
    v_mfma_f32_32x32x16_bf16 v[64:79], v[136:139], v[148:151], v[64:79]
    ds_read_b128 v[132:135], v238 offset:0
    ds_read_b64_tr_b16 v[120:121], v235 offset:0
    ds_read_b64_tr_b16 v[122:123], v235 offset:768
    v_mfma_f32_16x16x32_bf16 v[112:115], v[136:139], v[224:227], v[112:115]
    ds_read_b64_tr_b16 v[124:125], v236 offset:0
    ds_read_b64_tr_b16 v[126:127], v236 offset:768
    v_mfma_f32_32x32x16_bf16 v[80:95], v[140:143], v[148:151], v[80:95]
    ds_read_b64_tr_b16 v[128:129], v237 offset:0
    ds_read_b64_tr_b16 v[130:131], v237 offset:768
    v_mfma_f32_32x32x16_bf16 v[96:111], v[144:147], v[148:151], v[96:111]
    v_lshlrev_b32 v6, 3, v5
    v_lshrrev_b32 v7, v6, v7
    s_waitcnt lgkmcnt(7)
    v_mfma_f32_32x32x16_bf16 v[64:79], v[152:155], v[164:167], v[64:79]
    ds_read_b128 v[148:151], v239 offset:0
    ds_read_b64_tr_b16 v[136:137], v235 offset:3072
    ds_read_b64_tr_b16 v[138:139], v235 offset:3840
    v_mfma_f32_16x16x32_bf16 v[112:115], v[152:155], v[224:227], v[112:115]
    ds_read_b64_tr_b16 v[140:141], v236 offset:3072
    ds_read_b64_tr_b16 v[142:143], v236 offset:3840
    v_mfma_f32_32x32x16_bf16 v[80:95], v[156:159], v[164:167], v[80:95]
    ds_read_b64_tr_b16 v[144:145], v237 offset:3072
    ds_read_b64_tr_b16 v[146:147], v237 offset:3840
    v_mfma_f32_32x32x16_bf16 v[96:111], v[160:163], v[164:167], v[96:111]
    v_bfe_u32 v6, v7, 0, 1
    v_bfe_u32 v12, v7, 1, 1
    s_waitcnt lgkmcnt(7)
    v_mfma_f32_32x32x16_bf16 v[64:79], v[120:123], v[132:135], v[64:79]
    ds_read_b128 v[164:167], v240 offset:0
    ds_read_b64_tr_b16 v[152:153], v235 offset:6144
    ds_read_b64_tr_b16 v[154:155], v235 offset:6912
    v_mfma_f32_16x16x32_bf16 v[112:115], v[120:123], v[224:227], v[112:115]
    ds_read_b64_tr_b16 v[156:157], v236 offset:6144
    ds_read_b64_tr_b16 v[158:159], v236 offset:6912
    ds_read_b64_tr_b16 v[160:161], v237 offset:6144
    v_mfma_f32_32x32x16_bf16 v[80:95], v[124:127], v[132:135], v[80:95]
    ds_read_b64_tr_b16 v[162:163], v237 offset:6912
    ds_read_b128 v[168:171], v220 offset:384
    ds_read_b128 v[172:175], v220 offset:416
    v_mfma_f32_32x32x16_bf16 v[96:111], v[128:131], v[132:135], v[96:111]
    v_lshl_or_b32 v6, v12, 16, v6
    v_mul_u32_u24 v60, 0x3c00, v6
    s_waitcnt lgkmcnt(9)
    v_mfma_f32_32x32x16_bf16 v[64:79], v[136:139], v[148:151], v[64:79]
    ds_read_b128 v[132:135], v241 offset:0
    ds_read_b64_tr_b16 v[120:121], v235 offset:9216
    ds_read_b64_tr_b16 v[122:123], v235 offset:9984
    v_mfma_f32_16x16x32_bf16 v[112:115], v[136:139], v[224:227], v[112:115]
    ds_read_b64_tr_b16 v[124:125], v236 offset:9216
    ds_read_b64_tr_b16 v[126:127], v236 offset:9984
    ds_read_b64_tr_b16 v[128:129], v237 offset:9216
    v_mfma_f32_32x32x16_bf16 v[80:95], v[140:143], v[148:151], v[80:95]
    ds_read_b64_tr_b16 v[130:131], v237 offset:9984
    ds_read_b128 v[176:179], v220 offset:448
    ds_read_b128 v[180:183], v220 offset:480
    v_mfma_f32_32x32x16_bf16 v[96:111], v[144:147], v[148:151], v[96:111]
    v_bfe_u32 v6, v7, 2, 1
    v_bfe_u32 v12, v7, 3, 1
    s_barrier
    s_waitcnt lgkmcnt(11)
    v_mfma_f32_32x32x16_bf16 v[64:79], v[152:155], v[164:167], v[64:79]
    ds_read_b128 v[148:151], v238 offset:28672
    ds_read_b64_tr_b16 v[136:137], v235 offset:28672
    ds_read_b64_tr_b16 v[138:139], v235 offset:29440
    v_mfma_f32_16x16x32_bf16 v[112:115], v[152:155], v[224:227], v[112:115]
    ds_read_b64_tr_b16 v[140:141], v236 offset:28672
    ds_read_b64_tr_b16 v[142:143], v236 offset:29440
    ds_read_b64_tr_b16 v[144:145], v237 offset:28672
    v_mfma_f32_32x32x16_bf16 v[80:95], v[156:159], v[164:167], v[80:95]
    ds_read_b64_tr_b16 v[146:147], v237 offset:29440
    ds_read_b128 v[184:187], v221 offset:384
    ds_read_b128 v[188:191], v221 offset:416
    v_mfma_f32_32x32x16_bf16 v[96:111], v[160:163], v[164:167], v[96:111]
    v_lshl_or_b32 v6, v12, 16, v6
    v_mul_u32_u24 v61, 0x3c00, v6
    s_waitcnt lgkmcnt(11)
    v_mfma_f32_32x32x16_bf16 v[64:79], v[120:123], v[132:135], v[64:79]
    ds_read_b128 v[164:167], v239 offset:28672
    ds_read_b64_tr_b16 v[152:153], v235 offset:31744
    ds_read_b64_tr_b16 v[154:155], v235 offset:32512
    v_mfma_f32_16x16x32_bf16 v[112:115], v[120:123], v[224:227], v[112:115]
    ds_read_b64_tr_b16 v[156:157], v236 offset:31744
    ds_read_b64_tr_b16 v[158:159], v236 offset:32512
    ds_read_b64_tr_b16 v[160:161], v237 offset:31744
    v_mfma_f32_32x32x16_bf16 v[80:95], v[124:127], v[132:135], v[80:95]
    ds_read_b64_tr_b16 v[162:163], v237 offset:32512
    ds_read_b128 v[192:195], v221 offset:448
    ds_read_b128 v[196:199], v221 offset:480
    v_mfma_f32_32x32x16_bf16 v[96:111], v[128:131], v[132:135], v[96:111]
    v_bfe_u32 v6, v7, 4, 1
    v_bfe_u32 v12, v7, 5, 1
    s_waitcnt lgkmcnt(11)
    v_mfma_f32_32x32x16_bf16 v[64:79], v[136:139], v[148:151], v[64:79]
    ds_read_b128 v[132:135], v240 offset:28672
    ds_read_b64_tr_b16 v[120:121], v235 offset:34816
    ds_read_b64_tr_b16 v[122:123], v235 offset:35584
    v_mfma_f32_16x16x32_bf16 v[112:115], v[136:139], v[224:227], v[112:115]
    ds_read_b64_tr_b16 v[124:125], v236 offset:34816
    ds_read_b64_tr_b16 v[126:127], v236 offset:35584
    ds_read_b64_tr_b16 v[128:129], v237 offset:34816
    v_mfma_f32_32x32x16_bf16 v[80:95], v[140:143], v[148:151], v[80:95]
    ds_read_b64_tr_b16 v[130:131], v237 offset:35584
    ds_read_b128 v[200:203], v222 offset:384
    ds_read_b128 v[204:207], v222 offset:416
    v_mfma_f32_32x32x16_bf16 v[96:111], v[144:147], v[148:151], v[96:111]
    v_lshl_or_b32 v6, v12, 16, v6
    v_mul_u32_u24 v62, 0x3c00, v6
    s_waitcnt lgkmcnt(11)
    v_mfma_f32_32x32x16_bf16 v[64:79], v[152:155], v[164:167], v[64:79]
    ds_read_b128 v[148:151], v241 offset:28672
    ds_read_b64_tr_b16 v[136:137], v235 offset:37888
    ds_read_b64_tr_b16 v[138:139], v235 offset:38656
    v_mfma_f32_16x16x32_bf16 v[112:115], v[152:155], v[224:227], v[112:115]
    ds_read_b64_tr_b16 v[140:141], v236 offset:37888
    ds_read_b64_tr_b16 v[142:143], v236 offset:38656
    ds_read_b64_tr_b16 v[144:145], v237 offset:37888
    v_mfma_f32_32x32x16_bf16 v[80:95], v[156:159], v[164:167], v[80:95]
    ds_read_b64_tr_b16 v[146:147], v237 offset:38656
    ds_read_b128 v[208:211], v222 offset:448
    ds_read_b128 v[212:215], v222 offset:480
    v_mfma_f32_32x32x16_bf16 v[96:111], v[160:163], v[164:167], v[96:111]
    v_bfe_u32 v6, v7, 6, 1
    v_bfe_u32 v12, v7, 7, 1
    s_waitcnt lgkmcnt(11)
    v_mfma_f32_32x32x16_bf16 v[64:79], v[120:123], v[132:135], v[64:79]
    v_lshl_or_b32 v6, v12, 16, v6
    v_mfma_f32_16x16x32_bf16 v[112:115], v[120:123], v[224:227], v[112:115]
    v_mul_u32_u24 v63, 0x3c00, v6
    v_mfma_f32_32x32x16_bf16 v[80:95], v[124:127], v[132:135], v[80:95]
    v_mfma_f32_32x32x16_bf16 v[96:111], v[128:131], v[132:135], v[96:111]
    s_waitcnt lgkmcnt(2)
    s_barrier
    v_mfma_f32_32x32x16_bf16 v[64:79], v[136:139], v[148:151], v[64:79]
    v_mfma_f32_16x16x32_bf16 v[112:115], v[136:139], v[224:227], v[112:115]
    v_mfma_f32_32x32x16_bf16 v[80:95], v[140:143], v[148:151], v[80:95]
    v_mfma_f32_32x32x16_bf16 v[96:111], v[144:147], v[148:151], v[96:111]
    v_lshrrev_b32 v42, 5, v0
    v_lshlrev_b32 v42, 4, v42
    v_sub_u32 v42, v220, v42
    v_and_b32 v41, 15, v0
    v_lshl_add_u32 v42, v41, 6, v42
    v_lshrrev_b32 v40, 4, v0
    v_lshl_add_u32 v42, v40, 4, v42
    v_cmp_gt_u32 vcc, 2, v41
    s_nop 0
    s_mov_b64 exec, vcc
    ds_write_b128 v42, v[112:115]
    s_mov_b64 exec, -1
    s_waitcnt lgkmcnt(0)
    s_barrier
    s_waitcnt vmcnt(2)
    v_readfirstlane_b32 s63, v3
    s_nop 0
    s_not_b32 s63, s63
    s_bfe_u32 s74, s63, 0x1000f
    s_and_b32 s63, s63, 0x7fffffff
    s_lshl_b32 s74, s74, 31
    s_or_b32 s63, s63, s74
    s_and_b32 s65, s63, 0xffff
    s_and_b32 s64, s63, 0xffff0000
    s_and_b32 s11, s63, 0x10001
    s_and_b32 s4, s63, 0x80008000
    ds_read_b128 v[120:123], v220 offset:0
    ds_read_b128 v[124:127], v220 offset:32
    ds_read_b128 v[128:131], v220 offset:64
    ds_read_b128 v[132:135], v220 offset:96
    ds_read_b128 v[136:139], v221 offset:0
    ds_read_b128 v[140:143], v221 offset:32
    ds_read_b128 v[144:147], v221 offset:64
    ds_read_b128 v[148:151], v221 offset:96
    ds_read_b128 v[152:155], v222 offset:0
    ds_read_b128 v[156:159], v222 offset:32
    ds_read_b128 v[160:163], v222 offset:64
    ds_read_b128 v[164:167], v222 offset:96
    s_waitcnt vmcnt(0)
    s_mov_b32 s87, 0
L_st_chk:
    v_xor_b32 v40, s63, v217
    v_xor_b32 v41, s63, v219
    v_or_b32 v40, v40, v41
    v_cmp_ne_u32 vcc, 0, v40
    s_nop 4
    s_cbranch_vccz L_st_ok
    s_add_u32 s87, s87, 1
    s_cmp_ge_u32 s87, 4096
    s_cbranch_scc1 L_st_ok
    buffer_load_dwordx4 v[216:219], v47, s[52:55], s78 offen sc1
    s_waitcnt vmcnt(0)
    s_branch L_st_chk
L_st_ok:
    s_waitcnt lgkmcnt(8)
    v_pk_fma_f32 v[64:65], v[120:121], v[216:217], v[64:65] op_sel_hi:[1,0,1] neg_lo:[0,1,0] neg_hi:[0,1,0]
    v_pk_fma_f32 v[66:67], v[122:123], v[216:217], v[66:67] op_sel_hi:[1,0,1] neg_lo:[0,1,0] neg_hi:[0,1,0]
    v_pk_fma_f32 v[64:65], v[64:65], v[218:219], v[168:169] op_sel_hi:[1,0,1]
    v_pk_fma_f32 v[66:67], v[66:67], v[218:219], v[170:171] op_sel_hi:[1,0,1]
    v_max_f32 v64, 0, v64
    v_max_f32 v65, 0, v65
    v_max_f32 v66, 0, v66
    v_max_f32 v67, 0, v67
    v_pk_mul_f32 v[64:65], v[64:65], v[64:65]
    v_pk_mul_f32 v[66:67], v[66:67], v[66:67]
    v_cvt_pk_bf16_f32 v48, v64, v65
    v_cvt_pk_bf16_f32 v49, v66, v67
    v_pk_fma_f32 v[68:69], v[124:125], v[216:217], v[68:69] op_sel_hi:[1,0,1] neg_lo:[0,1,0] neg_hi:[0,1,0]
    v_pk_fma_f32 v[70:71], v[126:127], v[216:217], v[70:71] op_sel_hi:[1,0,1] neg_lo:[0,1,0] neg_hi:[0,1,0]
    v_pk_fma_f32 v[68:69], v[68:69], v[218:219], v[172:173] op_sel_hi:[1,0,1]
    v_pk_fma_f32 v[70:71], v[70:71], v[218:219], v[174:175] op_sel_hi:[1,0,1]
    v_max_f32 v68, 0, v68
    v_max_f32 v69, 0, v69
    v_max_f32 v70, 0, v70
    v_max_f32 v71, 0, v71
    v_pk_mul_f32 v[68:69], v[68:69], v[68:69]
    v_pk_mul_f32 v[70:71], v[70:71], v[70:71]
    v_cvt_pk_bf16_f32 v50, v68, v69
    v_cvt_pk_bf16_f32 v51, v70, v71
    v_or_b32 v48, s4, v48
    v_or_b32 v49, s4, v49
    v_or_b32 v50, s4, v50
    v_or_b32 v51, s4, v51
    s_nop 0
    v_permlane32_swap_b32 v48, v50
    v_permlane32_swap_b32 v49, v51
    buffer_store_dwordx4 v[48:51], v2, s[52:55], s85 offen sc1
    v_pk_fma_f32 v[72:73], v[128:129], v[216:217], v[72:73] op_sel_hi:[1,0,1] neg_lo:[0,1,0] neg_hi:[0,1,0]
    v_pk_fma_f32 v[74:75], v[130:131], v[216:217], v[74:75] op_sel_hi:[1,0,1] neg_lo:[0,1,0] neg_hi:[0,1,0]
    v_pk_fma_f32 v[72:73], v[72:73], v[218:219], v[176:177] op_sel_hi:[1,0,1]
    v_pk_fma_f32 v[74:75], v[74:75], v[218:219], v[178:179] op_sel_hi:[1,0,1]
    v_max_f32 v72, 0, v72
    v_max_f32 v73, 0, v73
    v_max_f32 v74, 0, v74
    v_max_f32 v75, 0, v75
    v_pk_mul_f32 v[72:73], v[72:73], v[72:73]
    v_pk_mul_f32 v[74:75], v[74:75], v[74:75]
    v_cvt_pk_bf16_f32 v52, v72, v73
    v_cvt_pk_bf16_f32 v53, v74, v75
    v_pk_fma_f32 v[76:77], v[132:133], v[216:217], v[76:77] op_sel_hi:[1,0,1] neg_lo:[0,1,0] neg_hi:[0,1,0]
    v_pk_fma_f32 v[78:79], v[134:135], v[216:217], v[78:79] op_sel_hi:[1,0,1] neg_lo:[0,1,0] neg_hi:[0,1,0]
    v_pk_fma_f32 v[76:77], v[76:77], v[218:219], v[180:181] op_sel_hi:[1,0,1]
    v_pk_fma_f32 v[78:79], v[78:79], v[218:219], v[182:183] op_sel_hi:[1,0,1]
    v_max_f32 v76, 0, v76
    v_max_f32 v77, 0, v77
    v_max_f32 v78, 0, v78
    v_max_f32 v79, 0, v79
    v_pk_mul_f32 v[76:77], v[76:77], v[76:77]
    v_pk_mul_f32 v[78:79], v[78:79], v[78:79]
    v_cvt_pk_bf16_f32 v54, v76, v77
    v_cvt_pk_bf16_f32 v55, v78, v79
    v_or_b32 v52, s4, v52
    v_or_b32 v53, s4, v53
    v_or_b32 v54, s4, v54
    v_or_b32 v55, s4, v55
    s_nop 0
    v_permlane32_swap_b32 v52, v54
    v_permlane32_swap_b32 v53, v55
    buffer_store_dwordx4 v[52:55], v2, s[52:55], s85 offen offset:1024 sc1
    s_waitcnt lgkmcnt(4)
    v_pk_fma_f32 v[80:81], v[136:137], v[216:217], v[80:81] op_sel_hi:[1,0,1] neg_lo:[0,1,0] neg_hi:[0,1,0]
    v_pk_fma_f32 v[82:83], v[138:139], v[216:217], v[82:83] op_sel_hi:[1,0,1] neg_lo:[0,1,0] neg_hi:[0,1,0]
    v_pk_fma_f32 v[80:81], v[80:81], v[218:219], v[184:185] op_sel_hi:[1,0,1]
    v_pk_fma_f32 v[82:83], v[82:83], v[218:219], v[186:187] op_sel_hi:[1,0,1]
    v_max_f32 v80, 0, v80
    v_max_f32 v81, 0, v81
    v_max_f32 v82, 0, v82
    v_max_f32 v83, 0, v83
    v_pk_mul_f32 v[80:81], v[80:81], v[80:81]
    v_pk_mul_f32 v[82:83], v[82:83], v[82:83]
    v_cvt_pk_bf16_f32 v48, v80, v81
    v_cvt_pk_bf16_f32 v49, v82, v83
    v_pk_fma_f32 v[84:85], v[140:141], v[216:217], v[84:85] op_sel_hi:[1,0,1] neg_lo:[0,1,0] neg_hi:[0,1,0]
    v_pk_fma_f32 v[86:87], v[142:143], v[216:217], v[86:87] op_sel_hi:[1,0,1] neg_lo:[0,1,0] neg_hi:[0,1,0]
    v_pk_fma_f32 v[84:85], v[84:85], v[218:219], v[188:189] op_sel_hi:[1,0,1]
    v_pk_fma_f32 v[86:87], v[86:87], v[218:219], v[190:191] op_sel_hi:[1,0,1]
    v_max_f32 v84, 0, v84
    v_max_f32 v85, 0, v85
    v_max_f32 v86, 0, v86
    v_max_f32 v87, 0, v87
    v_pk_mul_f32 v[84:85], v[84:85], v[84:85]
    v_pk_mul_f32 v[86:87], v[86:87], v[86:87]
    v_cvt_pk_bf16_f32 v50, v84, v85
    v_cvt_pk_bf16_f32 v51, v86, v87
    v_or_b32 v48, s4, v48
    v_or_b32 v49, s4, v49
    v_or_b32 v50, s4, v50
    v_or_b32 v51, s4, v51
    s_nop 0
    v_permlane32_swap_b32 v48, v50
    v_permlane32_swap_b32 v49, v51
    buffer_store_dwordx4 v[48:51], v2, s[52:55], s86 offen sc1
    v_pk_fma_f32 v[88:89], v[144:145], v[216:217], v[88:89] op_sel_hi:[1,0,1] neg_lo:[0,1,0] neg_hi:[0,1,0]
    v_pk_fma_f32 v[90:91], v[146:147], v[216:217], v[90:91] op_sel_hi:[1,0,1] neg_lo:[0,1,0] neg_hi:[0,1,0]
    v_pk_fma_f32 v[88:89], v[88:89], v[218:219], v[192:193] op_sel_hi:[1,0,1]
    v_pk_fma_f32 v[90:91], v[90:91], v[218:219], v[194:195] op_sel_hi:[1,0,1]
    v_max_f32 v88, 0, v88
    v_max_f32 v89, 0, v89
    v_max_f32 v90, 0, v90
    v_max_f32 v91, 0, v91
    v_pk_mul_f32 v[88:89], v[88:89], v[88:89]
    v_pk_mul_f32 v[90:91], v[90:91], v[90:91]
    v_cvt_pk_bf16_f32 v52, v88, v89
    v_cvt_pk_bf16_f32 v53, v90, v91
    v_pk_fma_f32 v[92:93], v[148:149], v[216:217], v[92:93] op_sel_hi:[1,0,1] neg_lo:[0,1,0] neg_hi:[0,1,0]
    v_pk_fma_f32 v[94:95], v[150:151], v[216:217], v[94:95] op_sel_hi:[1,0,1] neg_lo:[0,1,0] neg_hi:[0,1,0]
    v_pk_fma_f32 v[92:93], v[92:93], v[218:219], v[196:197] op_sel_hi:[1,0,1]
    v_pk_fma_f32 v[94:95], v[94:95], v[218:219], v[198:199] op_sel_hi:[1,0,1]
    v_max_f32 v92, 0, v92
    v_max_f32 v93, 0, v93
    v_max_f32 v94, 0, v94
    v_max_f32 v95, 0, v95
    v_pk_mul_f32 v[92:93], v[92:93], v[92:93]
    v_pk_mul_f32 v[94:95], v[94:95], v[94:95]
    v_cvt_pk_bf16_f32 v54, v92, v93
    v_cvt_pk_bf16_f32 v55, v94, v95
    v_or_b32 v52, s4, v52
    v_or_b32 v53, s4, v53
    v_or_b32 v54, s4, v54
    v_or_b32 v55, s4, v55
    s_nop 0
    v_permlane32_swap_b32 v52, v54
    v_permlane32_swap_b32 v53, v55
    buffer_store_dwordx4 v[52:55], v2, s[52:55], s86 offen offset:1024 sc1
    s_waitcnt lgkmcnt(0)
    v_pk_fma_f32 v[96:97], v[152:153], v[216:217], v[96:97] op_sel_hi:[1,0,1] neg_lo:[0,1,0] neg_hi:[0,1,0]
    v_pk_fma_f32 v[98:99], v[154:155], v[216:217], v[98:99] op_sel_hi:[1,0,1] neg_lo:[0,1,0] neg_hi:[0,1,0]
    v_pk_fma_f32 v[96:97], v[96:97], v[218:219], v[200:201] op_sel_hi:[1,0,1]
    v_pk_fma_f32 v[98:99], v[98:99], v[218:219], v[202:203] op_sel_hi:[1,0,1]
    v_max_f32 v96, 0, v96
    v_max_f32 v97, 0, v97
    v_max_f32 v98, 0, v98
    v_max_f32 v99, 0, v99
    v_pk_mul_f32 v[96:97], v[96:97], v[96:97]
    v_pk_mul_f32 v[98:99], v[98:99], v[98:99]
    v_cvt_pk_bf16_f32 v48, v96, v97
    v_cvt_pk_bf16_f32 v49, v98, v99
    v_pk_fma_f32 v[100:101], v[156:157], v[216:217], v[100:101] op_sel_hi:[1,0,1] neg_lo:[0,1,0] neg_hi:[0,1,0]
    v_pk_fma_f32 v[102:103], v[158:159], v[216:217], v[102:103] op_sel_hi:[1,0,1] neg_lo:[0,1,0] neg_hi:[0,1,0]
    v_pk_fma_f32 v[100:101], v[100:101], v[218:219], v[204:205] op_sel_hi:[1,0,1]
    v_pk_fma_f32 v[102:103], v[102:103], v[218:219], v[206:207] op_sel_hi:[1,0,1]
    v_max_f32 v100, 0, v100
    v_max_f32 v101, 0, v101
    v_max_f32 v102, 0, v102
    v_max_f32 v103, 0, v103
    v_pk_mul_f32 v[100:101], v[100:101], v[100:101]
    v_pk_mul_f32 v[102:103], v[102:103], v[102:103]
    v_cvt_pk_bf16_f32 v50, v100, v101
    v_cvt_pk_bf16_f32 v51, v102, v103
    v_or_b32 v48, s4, v48
    v_or_b32 v49, s4, v49
    v_or_b32 v50, s4, v50
    v_or_b32 v51, s4, v51
    s_nop 0
    v_permlane32_swap_b32 v48, v50
    v_permlane32_swap_b32 v49, v51
    buffer_store_dwordx4 v[48:51], v2, s[52:55], s13 offen sc1
    v_pk_fma_f32 v[104:105], v[160:161], v[216:217], v[104:105] op_sel_hi:[1,0,1] neg_lo:[0,1,0] neg_hi:[0,1,0]
    v_pk_fma_f32 v[106:107], v[162:163], v[216:217], v[106:107] op_sel_hi:[1,0,1] neg_lo:[0,1,0] neg_hi:[0,1,0]
    v_pk_fma_f32 v[104:105], v[104:105], v[218:219], v[208:209] op_sel_hi:[1,0,1]
    v_pk_fma_f32 v[106:107], v[106:107], v[218:219], v[210:211] op_sel_hi:[1,0,1]
    v_max_f32 v104, 0, v104
    v_max_f32 v105, 0, v105
    v_max_f32 v106, 0, v106
    v_max_f32 v107, 0, v107
    v_pk_mul_f32 v[104:105], v[104:105], v[104:105]
    v_pk_mul_f32 v[106:107], v[106:107], v[106:107]
    v_cvt_pk_bf16_f32 v52, v104, v105
    v_cvt_pk_bf16_f32 v53, v106, v107
    v_pk_fma_f32 v[108:109], v[164:165], v[216:217], v[108:109] op_sel_hi:[1,0,1] neg_lo:[0,1,0] neg_hi:[0,1,0]
    v_pk_fma_f32 v[110:111], v[166:167], v[216:217], v[110:111] op_sel_hi:[1,0,1] neg_lo:[0,1,0] neg_hi:[0,1,0]
    v_pk_fma_f32 v[108:109], v[108:109], v[218:219], v[212:213] op_sel_hi:[1,0,1]
    v_pk_fma_f32 v[110:111], v[110:111], v[218:219], v[214:215] op_sel_hi:[1,0,1]
    v_max_f32 v108, 0, v108
    v_max_f32 v109, 0, v109
    v_max_f32 v110, 0, v110
    v_max_f32 v111, 0, v111
    v_pk_mul_f32 v[108:109], v[108:109], v[108:109]
    v_pk_mul_f32 v[110:111], v[110:111], v[110:111]
    v_cvt_pk_bf16_f32 v54, v108, v109
    v_cvt_pk_bf16_f32 v55, v110, v111
    v_or_b32 v52, s4, v52
    v_or_b32 v53, s4, v53
    v_or_b32 v54, s4, v54
    v_or_b32 v55, s4, v55
    s_nop 0
    v_permlane32_swap_b32 v52, v54
    v_permlane32_swap_b32 v53, v55
    buffer_store_dwordx4 v[52:55], v2, s[52:55], s13 offen offset:1024 sc1
L_epi_done:
    s_barrier
    v_lshrrev_b32 v30, 3, v1
    v_add_u32 v30, s72, v30
    v_lshlrev_b32 v30, 10, v30
    v_and_b32 v31, 7, v1
    v_lshlrev_b32 v31, 4, v31
    s_lshl_b32 s74, s73, 1
    v_add3_u32 v30, v30, v31, s74
    buffer_load_dwordx4 v[232:235], v30, s[40:43], 0 offen
    s_lshr_b32 s74, s60, 1
    s_and_b32 s75, s60, 1
    s_lshr_b32 s76, s72, 5
    s_add_u32 s76, s76, s75
    s_mul_i32 s76, s76, 86
    s_mul_i32 s77, s74, 43
    s_add_u32 s76, s76, s77
    s_lshl_b32 s76, s76, 10
    s_add_u32 s85, s76, 9437184
    s_bitcmp1_b32 s60, 0
    s_cbranch_scc1 L_convB
    ds_read_b128 v[64:67], v8 offset:480
    ds_read_b128 v[68:71], v8 offset:992
    ds_read_b128 v[72:75], v8 offset:496
    ds_read_b128 v[76:79], v8 offset:1008
    s_waitcnt lgkmcnt(3)
    v_mfma_f32_16x16x32_f16 v[96:99], v[64:67], v[56:59], 0
    ds_read_b64 v[128:129], v10 offset:2272
    s_waitcnt lgkmcnt(3)
    v_mfma_f32_16x16x32_f16 v[100:103], v[68:71], v[56:59], 0
    ds_read_b64 v[130:131], v10 offset:2304
    s_waitcnt lgkmcnt(3)
    v_mfma_f32_16x16x32_f16 v[104:107], v[72:75], v[60:63], 0
    ds_read_b64 v[132:133], v10 offset:2480
    s_waitcnt lgkmcnt(3)
    v_mfma_f32_16x16x32_f16 v[108:111], v[76:79], v[60:63], 0
    ds_read_b64 v[134:135], v10 offset:2512
    v_cvt_pk_f16_f32 v32, v96, v97
    v_cvt_pk_f16_f32 v33, v98, v99
    v_cvt_pk_f16_f32 v34, v100, v101
    v_cvt_pk_f16_f32 v35, v102, v103
    v_cvt_pk_f16_f32 v40, v104, v105
    v_cvt_pk_f16_f32 v41, v106, v107
    s_nop 0
    v_cvt_pk_f16_f32 v42, v108, v109
    v_cvt_pk_f16_f32 v43, v110, v111
    s_waitcnt lgkmcnt(2)
    v_mfma_f32_16x16x32_f16 v[212:215], v[32:35], v[128:131], 0
    ds_read_b64 v[64:65], v9 offset:2048
    ds_read_b64 v[66:67], v9 offset:2056
    ds_read_b128 v[216:219], v8 offset:2560
    ds_read_b64 v[68:69], v9 offset:1984
    ds_read_b64 v[70:71], v9 offset:1992
    ds_read_b128 v[220:223], v8 offset:2496
    ds_read_b64 v[72:73], v9 offset:1920
    ds_read_b64 v[74:75], v9 offset:1928
    s_waitcnt lgkmcnt(8)
    v_mfma_f32_16x16x32_f16 v[212:215], v[40:43], v[132:135], v[212:215]
    ds_read_b128 v[224:227], v8 offset:2432
    ds_read_b64 v[76:77], v9 offset:1856
    ds_read_b64 v[78:79], v9 offset:1864
    ds_read_b128 v[228:231], v8 offset:2368
    ds_read_b64 v[80:81], v9 offset:1792
    ds_read_b64 v[82:83], v9 offset:1800
    ds_read_b128 v[236:239], v8 offset:2304
    s_waitcnt lgkmcnt(12)
    v_mfma_f32_16x16x32_f16 v[212:215], v[64:67], v[216:219], v[212:215]
    ds_read_b64 v[84:85], v9 offset:1728
    ds_read_b64 v[86:87], v9 offset:1736
    ds_read_b128 v[240:243], v8 offset:2240
    s_waitcnt lgkmcnt(12)
    v_mfma_f32_16x16x32_f16 v[212:215], v[68:71], v[220:223], v[212:215]
    ds_read_b64 v[88:89], v9 offset:1664
    ds_read_b64 v[90:91], v9 offset:1672
    ds_read_b128 v[216:219], v8 offset:2176
    s_waitcnt lgkmcnt(12)
    v_mfma_f32_16x16x32_f16 v[212:215], v[72:75], v[224:227], v[212:215]
    ds_read_b64 v[92:93], v9 offset:1600
    ds_read_b64 v[94:95], v9 offset:1608
    ds_read_b128 v[220:223], v8 offset:2112
    s_waitcnt lgkmcnt(12)
    v_mfma_f32_16x16x32_f16 v[212:215], v[76:79], v[228:231], v[212:215]
    ds_read_b64 v[96:97], v9 offset:1536
    ds_read_b64 v[98:99], v9 offset:1544
    ds_read_b128 v[224:227], v8 offset:2048
    s_waitcnt lgkmcnt(12)
    v_mfma_f32_16x16x32_f16 v[212:215], v[80:83], v[236:239], v[212:215]
    ds_read_b64 v[100:101], v9 offset:1472
    ds_read_b64 v[102:103], v9 offset:1480
    ds_read_b128 v[228:231], v8 offset:1984
    s_waitcnt lgkmcnt(12)
    v_mfma_f32_16x16x32_f16 v[212:215], v[84:87], v[240:243], v[212:215]
    ds_read_b64 v[104:105], v9 offset:1408
    ds_read_b64 v[106:107], v9 offset:1416
    ds_read_b128 v[236:239], v8 offset:1920
    s_waitcnt lgkmcnt(12)
    v_mfma_f32_16x16x32_f16 v[212:215], v[88:91], v[216:219], v[212:215]
    ds_read_b64 v[108:109], v9 offset:1344
    ds_read_b64 v[110:111], v9 offset:1352
    ds_read_b128 v[240:243], v8 offset:1856
    s_waitcnt lgkmcnt(12)
    v_mfma_f32_16x16x32_f16 v[212:215], v[92:95], v[220:223], v[212:215]
    ds_read_b64 v[112:113], v9 offset:1280
    ds_read_b64 v[114:115], v9 offset:1288
    ds_read_b128 v[216:219], v8 offset:1792
    s_waitcnt lgkmcnt(12)
    v_mfma_f32_16x16x32_f16 v[208:211], v[64:67], v[224:227], 0
    ds_read_b64 v[116:117], v9 offset:1216
    ds_read_b64 v[118:119], v9 offset:1224
    v_mfma_f32_16x16x32_f16 v[212:215], v[96:99], v[224:227], v[212:215]
    ds_read_b128 v[220:223], v8 offset:1728
    s_waitcnt lgkmcnt(12)
    v_mfma_f32_16x16x32_f16 v[208:211], v[68:71], v[228:231], v[208:211]
    ds_read_b64 v[120:121], v9 offset:1152
    ds_read_b64 v[122:123], v9 offset:1160
    v_mfma_f32_16x16x32_f16 v[212:215], v[100:103], v[228:231], v[212:215]
    ds_read_b128 v[224:227], v8 offset:1664
    s_waitcnt lgkmcnt(12)
    v_mfma_f32_16x16x32_f16 v[208:211], v[72:75], v[236:239], v[208:211]
    ds_read_b64 v[124:125], v9 offset:1088
    ds_read_b64 v[126:127], v9 offset:1096
    v_mfma_f32_16x16x32_f16 v[212:215], v[104:107], v[236:239], v[212:215]
    ds_read_b128 v[228:231], v8 offset:1600
    s_waitcnt lgkmcnt(12)
    v_mfma_f32_16x16x32_f16 v[208:211], v[76:79], v[240:243], v[208:211]
    ds_read_b64 v[128:129], v9 offset:1024
    ds_read_b64 v[130:131], v9 offset:1032
    v_mfma_f32_16x16x32_f16 v[212:215], v[108:111], v[240:243], v[212:215]
    ds_read_b128 v[236:239], v8 offset:1536
    s_waitcnt lgkmcnt(12)
    v_mfma_f32_16x16x32_f16 v[208:211], v[80:83], v[216:219], v[208:211]
    ds_read_b64 v[132:133], v9 offset:960
    ds_read_b64 v[134:135], v9 offset:968
    v_mfma_f32_16x16x32_f16 v[212:215], v[112:115], v[216:219], v[212:215]
    ds_read_b128 v[240:243], v8 offset:1472
    s_waitcnt lgkmcnt(12)
    v_mfma_f32_16x16x32_f16 v[208:211], v[84:87], v[220:223], v[208:211]
    ds_read_b64 v[136:137], v9 offset:896
    ds_read_b64 v[138:139], v9 offset:904
    v_mfma_f32_16x16x32_f16 v[212:215], v[116:119], v[220:223], v[212:215]
    ds_read_b128 v[216:219], v8 offset:1408
    s_waitcnt lgkmcnt(12)
    v_mfma_f32_16x16x32_f16 v[208:211], v[88:91], v[224:227], v[208:211]
    ds_read_b64 v[140:141], v9 offset:832
    ds_read_b64 v[142:143], v9 offset:840
    v_mfma_f32_16x16x32_f16 v[212:215], v[120:123], v[224:227], v[212:215]
    ds_read_b128 v[220:223], v8 offset:1344
    s_waitcnt lgkmcnt(12)
    v_mfma_f32_16x16x32_f16 v[208:211], v[92:95], v[228:231], v[208:211]
    ds_read_b64 v[144:145], v9 offset:768
    ds_read_b64 v[146:147], v9 offset:776
    v_mfma_f32_16x16x32_f16 v[212:215], v[124:127], v[228:231], v[212:215]
    ds_read_b128 v[224:227], v8 offset:1280
    s_waitcnt lgkmcnt(12)
    v_mfma_f32_16x16x32_f16 v[204:207], v[64:67], v[236:239], 0
    ds_read_b64 v[148:149], v9 offset:704
    v_mfma_f32_16x16x32_f16 v[208:211], v[96:99], v[236:239], v[208:211]
    ds_read_b64 v[150:151], v9 offset:712
    v_mfma_f32_16x16x32_f16 v[212:215], v[128:131], v[236:239], v[212:215]
    ds_read_b128 v[228:231], v8 offset:1216
    s_waitcnt lgkmcnt(12)
    v_mfma_f32_16x16x32_f16 v[204:207], v[68:71], v[240:243], v[204:207]
    ds_read_b64 v[152:153], v9 offset:640
    v_mfma_f32_16x16x32_f16 v[208:211], v[100:103], v[240:243], v[208:211]
    ds_read_b64 v[154:155], v9 offset:648
    v_mfma_f32_16x16x32_f16 v[212:215], v[132:135], v[240:243], v[212:215]
    ds_read_b128 v[236:239], v8 offset:1152
    s_waitcnt lgkmcnt(12)
    v_mfma_f32_16x16x32_f16 v[204:207], v[72:75], v[216:219], v[204:207]
    ds_read_b64 v[156:157], v9 offset:576
    v_mfma_f32_16x16x32_f16 v[208:211], v[104:107], v[216:219], v[208:211]
    ds_read_b64 v[158:159], v9 offset:584
    v_mfma_f32_16x16x32_f16 v[212:215], v[136:139], v[216:219], v[212:215]
    ds_read_b128 v[240:243], v8 offset:1088
    s_waitcnt lgkmcnt(12)
    v_mfma_f32_16x16x32_f16 v[204:207], v[76:79], v[220:223], v[204:207]
    ds_read_b64 v[160:161], v9 offset:512
    v_mfma_f32_16x16x32_f16 v[208:211], v[108:111], v[220:223], v[208:211]
    ds_read_b64 v[162:163], v9 offset:520
    v_mfma_f32_16x16x32_f16 v[212:215], v[140:143], v[220:223], v[212:215]
    ds_read_b128 v[216:219], v8 offset:1024
    s_waitcnt lgkmcnt(12)
    v_mfma_f32_16x16x32_f16 v[204:207], v[80:83], v[224:227], v[204:207]
    ds_read_b64 v[164:165], v9 offset:448
    v_mfma_f32_16x16x32_f16 v[208:211], v[112:115], v[224:227], v[208:211]
    ds_read_b64 v[166:167], v9 offset:456
    v_mfma_f32_16x16x32_f16 v[212:215], v[144:147], v[224:227], v[212:215]
    ds_read_b128 v[220:223], v8 offset:960
    s_waitcnt lgkmcnt(12)
    v_mfma_f32_16x16x32_f16 v[204:207], v[84:87], v[228:231], v[204:207]
    ds_read_b64 v[168:169], v9 offset:384
    v_mfma_f32_16x16x32_f16 v[208:211], v[116:119], v[228:231], v[208:211]
    ds_read_b64 v[170:171], v9 offset:392
    v_mfma_f32_16x16x32_f16 v[212:215], v[148:151], v[228:231], v[212:215]
    ds_read_b128 v[224:227], v8 offset:896
    s_waitcnt lgkmcnt(12)
    v_mfma_f32_16x16x32_f16 v[204:207], v[88:91], v[236:239], v[204:207]
    ds_read_b64 v[172:173], v9 offset:320
    v_mfma_f32_16x16x32_f16 v[208:211], v[120:123], v[236:239], v[208:211]
    ds_read_b64 v[174:175], v9 offset:328
    v_mfma_f32_16x16x32_f16 v[212:215], v[152:155], v[236:239], v[212:215]
    ds_read_b128 v[228:231], v8 offset:832
    s_waitcnt lgkmcnt(12)
    v_mfma_f32_16x16x32_f16 v[204:207], v[92:95], v[240:243], v[204:207]
    ds_read_b64 v[176:177], v9 offset:256
    v_mfma_f32_16x16x32_f16 v[208:211], v[124:127], v[240:243], v[208:211]
    ds_read_b64 v[178:179], v9 offset:264
    v_mfma_f32_16x16x32_f16 v[212:215], v[156:159], v[240:243], v[212:215]
    ds_read_b128 v[236:239], v8 offset:768
    s_waitcnt lgkmcnt(12)
    v_mfma_f32_16x16x32_f16 v[200:203], v[64:67], v[216:219], 0
    ds_read_b64 v[180:181], v9 offset:192
    v_mfma_f32_16x16x32_f16 v[204:207], v[96:99], v[216:219], v[204:207]
    ds_read_b64 v[182:183], v9 offset:200
    v_mfma_f32_16x16x32_f16 v[208:211], v[128:131], v[216:219], v[208:211]
    ds_read_b128 v[240:243], v8 offset:704
    v_mfma_f32_16x16x32_f16 v[212:215], v[160:163], v[216:219], v[212:215]
    s_waitcnt lgkmcnt(12)
    v_mfma_f32_16x16x32_f16 v[200:203], v[68:71], v[220:223], v[200:203]
    ds_read_b64 v[184:185], v9 offset:128
    ds_read_b64 v[186:187], v9 offset:136
    ds_read_b128 v[216:219], v8 offset:640
    v_mfma_f32_16x16x32_f16 v[204:207], v[100:103], v[220:223], v[204:207]
    s_lshr_b32 s74, s60, 1
    s_and_b32 s75, s60, 1
    s_lshr_b32 s76, s72, 5
    v_mfma_f32_16x16x32_f16 v[208:211], v[132:135], v[220:223], v[208:211]
    s_add_u32 s76, s76, s75
    s_mul_i32 s76, s76, 86
    s_mul_i32 s77, s74, 43
    v_mfma_f32_16x16x32_f16 v[212:215], v[164:167], v[220:223], v[212:215]
    s_add_u32 s76, s76, s77
    s_lshl_b32 s76, s76, 10
    s_waitcnt lgkmcnt(12)
    v_mfma_f32_16x16x32_f16 v[200:203], v[72:75], v[224:227], v[200:203]
    ds_read_b64 v[188:189], v9 offset:64
    ds_read_b64 v[190:191], v9 offset:72
    ds_read_b128 v[220:223], v8 offset:576
    v_mfma_f32_16x16x32_f16 v[204:207], v[104:107], v[224:227], v[204:207]
    s_add_u32 s85, s76, 9437184
    v_lshrrev_b32 v33, 5, v0
    v_lshlrev_b32 v33, 3, v33
    v_mfma_f32_16x16x32_f16 v[208:211], v[136:139], v[224:227], v[208:211]
    v_bfe_u32 v34, v0, 2, 2
    v_add_u32 v33, v33, v34
    v_lshlrev_b32 v33, 7, v33
    v_mfma_f32_16x16x32_f16 v[212:215], v[168:171], v[224:227], v[212:215]
    v_bfe_u32 v34, v0, 4, 1
    v_lshlrev_b32 v34, 1, v34
    s_waitcnt lgkmcnt(12)
    v_mfma_f32_16x16x32_f16 v[200:203], v[76:79], v[228:231], v[200:203]
    ds_read_b64 v[192:193], v9 offset:0
    ds_read_b64 v[194:195], v9 offset:8
    ds_read_b128 v[224:227], v8 offset:512
    v_mfma_f32_16x16x32_f16 v[204:207], v[108:111], v[228:231], v[204:207]
    v_bfe_u32 v35, v0, 1, 1
    v_add_u32 v34, v34, v35
    s_lshl_b32 s77, s74, 2
    v_mfma_f32_16x16x32_f16 v[208:211], v[140:143], v[228:231], v[208:211]
    v_or_b32 v34, s77, v34
    v_bfe_u32 v35, v0, 3, 1
    v_lshlrev_b32 v35, 2, v35
    v_mfma_f32_16x16x32_f16 v[212:215], v[172:175], v[228:231], v[212:215]
    v_xor_b32 v34, v34, v35
    v_lshl_add_u32 v33, v34, 4, v33
    s_waitcnt lgkmcnt(12)
    v_mfma_f32_16x16x32_f16 v[200:203], v[80:83], v[236:239], v[200:203]
    ds_read_b128 v[228:231], v8 offset:448
    v_and_b32 v34, 1, v0
    v_lshl_add_u32 v33, v34, 3, v33
    v_mfma_f32_16x16x32_f16 v[204:207], v[112:115], v[236:239], v[204:207]
    s_lshl_b32 s77, s74, 13
    v_add_u32 v24, s77, v33
    v_mfma_f32_16x16x32_f16 v[208:211], v[144:147], v[236:239], v[208:211]
    v_xor_b32 v25, 64, v24
    s_mov_b32 s12, 49152
    v_mfma_f32_16x16x32_f16 v[212:215], v[176:179], v[236:239], v[212:215]
    v_add_u32 v26, 65536, v24
    v_add_u32 v27, 65536, v25
    s_waitcnt lgkmcnt(10)
    v_mfma_f32_16x16x32_f16 v[200:203], v[84:87], v[240:243], v[200:203]
    ds_read_b128 v[236:239], v8 offset:384
    v_add_u32 v36, 114688, v24
    v_add_u32 v37, 114688, v25
    v_mfma_f32_16x16x32_f16 v[204:207], v[116:119], v[240:243], v[204:207]
    s_lshr_b32 s74, s60, 1
    s_lshl_b32 s74, s74, 5
    v_mfma_f32_16x16x32_f16 v[208:211], v[148:151], v[240:243], v[208:211]
    s_add_u32 s74, s74, s73
    v_and_b32 v28, 31, v0
    v_mfma_f32_16x16x32_f16 v[212:215], v[180:183], v[240:243], v[212:215]
    v_add_u32 v28, s74, v28
    v_lshlrev_b32 v29, 3, v28
    s_waitcnt lgkmcnt(8)
    v_mfma_f32_16x16x32_f16 v[200:203], v[88:91], v[216:219], v[200:203]
    ds_read_b128 v[240:243], v8 offset:320
    v_lshlrev_b32 v28, 12, v28
    v_lshrrev_b32 v31, 5, v0
    v_mfma_f32_16x16x32_f16 v[204:207], v[120:123], v[216:219], v[204:207]
    v_lshl_add_u32 v28, v31, 5, v28
    s_and_b32 s75, s60, 1
    v_mfma_f32_16x16x32_f16 v[208:211], v[152:155], v[216:219], v[208:211]
    s_lshl_b32 s75, s75, 5
    s_add_u32 s75, s75, s72
    v_mfma_f32_16x16x32_f16 v[212:215], v[184:187], v[216:219], v[212:215]
    s_lshl_b32 s75, s75, 1
    s_add_u32 s80, s75, 5242880
    s_waitcnt lgkmcnt(6)
    v_mfma_f32_16x16x32_f16 v[200:203], v[92:95], v[220:223], v[200:203]
    ds_read_b128 v[216:219], v8 offset:256
    s_add_u32 s24, s101, 0
    s_cmp_ge_u32 s24, 10
    v_mfma_f32_16x16x32_f16 v[204:207], v[124:127], v[220:223], v[204:207]
    s_cselect_b32 s91, 10, 0
    s_sub_u32 s24, s24, s91
    v_mfma_f32_16x16x32_f16 v[208:211], v[156:159], v[220:223], v[208:211]
    s_lshl_b32 s24, s24, 12
    s_add_u32 s24, s24, s85
    v_mfma_f32_16x16x32_f16 v[212:215], v[188:191], v[220:223], v[212:215]
    s_add_u32 s25, s101, 1
    s_cmp_ge_u32 s25, 10
    s_waitcnt lgkmcnt(4)
    v_mfma_f32_16x16x32_f16 v[196:199], v[64:67], v[224:227], 0
    ds_read_b128 v[220:223], v8 offset:192
    s_cselect_b32 s91, 10, 0
    v_mfma_f32_16x16x32_f16 v[200:203], v[96:99], v[224:227], v[200:203]
    s_sub_u32 s25, s25, s91
    s_lshl_b32 s25, s25, 12
    v_mfma_f32_16x16x32_f16 v[204:207], v[128:131], v[224:227], v[204:207]
    s_add_u32 s25, s25, s85
    s_add_u32 s26, s101, 2
    v_mfma_f32_16x16x32_f16 v[208:211], v[160:163], v[224:227], v[208:211]
    s_cmp_ge_u32 s26, 10
    s_cselect_b32 s91, 10, 0
    v_mfma_f32_16x16x32_f16 v[212:215], v[192:195], v[224:227], v[212:215]
    s_sub_u32 s26, s26, s91
    s_waitcnt lgkmcnt(4)
    v_mfma_f32_16x16x32_f16 v[196:199], v[68:71], v[228:231], v[196:199]
    ds_read_b128 v[224:227], v8 offset:128
    s_lshl_b32 s26, s26, 12
    s_add_u32 s26, s26, s85
    v_mfma_f32_16x16x32_f16 v[200:203], v[100:103], v[228:231], v[200:203]
    s_add_u32 s27, s101, 3
    s_cmp_ge_u32 s27, 10
    v_mfma_f32_16x16x32_f16 v[204:207], v[132:135], v[228:231], v[204:207]
    s_cselect_b32 s91, 10, 0
    s_sub_u32 s27, s27, s91
    v_mfma_f32_16x16x32_f16 v[208:211], v[164:167], v[228:231], v[208:211]
    s_lshl_b32 s27, s27, 12
    s_add_u32 s27, s27, s85
    s_waitcnt lgkmcnt(4)
    v_mfma_f32_16x16x32_f16 v[196:199], v[72:75], v[236:239], v[196:199]
    ds_read_b128 v[228:231], v8 offset:64
    s_add_u32 s13, s101, 4
    s_cmp_ge_u32 s13, 10
    v_mfma_f32_16x16x32_f16 v[200:203], v[104:107], v[236:239], v[200:203]
    s_cselect_b32 s91, 10, 0
    s_sub_u32 s13, s13, s91
    v_mfma_f32_16x16x32_f16 v[204:207], v[136:139], v[236:239], v[204:207]
    s_lshl_b32 s13, s13, 12
    s_add_u32 s13, s13, s85
    v_mfma_f32_16x16x32_f16 v[208:211], v[168:171], v[236:239], v[208:211]
    s_add_u32 s14, s101, 5
    s_cmp_ge_u32 s14, 10
    s_waitcnt lgkmcnt(4)
    v_mfma_f32_16x16x32_f16 v[196:199], v[76:79], v[240:243], v[196:199]
    ds_read_b128 v[236:239], v8 offset:0
    s_cselect_b32 s91, 10, 0
    s_sub_u32 s14, s14, s91
    v_mfma_f32_16x16x32_f16 v[200:203], v[108:111], v[240:243], v[200:203]
    s_lshl_b32 s14, s14, 12
    s_add_u32 s14, s14, s85
    v_mfma_f32_16x16x32_f16 v[204:207], v[140:143], v[240:243], v[204:207]
    s_add_u32 s15, s101, 6
    s_cmp_ge_u32 s15, 10
    v_mfma_f32_16x16x32_f16 v[208:211], v[172:175], v[240:243], v[208:211]
    s_cselect_b32 s91, 10, 0
    s_sub_u32 s15, s15, s91
    s_waitcnt lgkmcnt(4)
    v_mfma_f32_16x16x32_f16 v[196:199], v[80:83], v[216:219], v[196:199]
    s_lshl_b32 s15, s15, 12
    s_add_u32 s15, s15, s85
    v_mfma_f32_16x16x32_f16 v[200:203], v[112:115], v[216:219], v[200:203]
    s_add_u32 s16, s101, 7
    s_cmp_ge_u32 s16, 10
    v_mfma_f32_16x16x32_f16 v[204:207], v[144:147], v[216:219], v[204:207]
    s_cselect_b32 s91, 10, 0
    s_sub_u32 s16, s16, s91
    v_mfma_f32_16x16x32_f16 v[208:211], v[176:179], v[216:219], v[208:211]
    s_lshl_b32 s16, s16, 12
    s_add_u32 s16, s16, s85
    s_waitcnt lgkmcnt(3)
    v_mfma_f32_16x16x32_f16 v[196:199], v[84:87], v[220:223], v[196:199]
    s_add_u32 s17, s101, 8
    s_cmp_ge_u32 s17, 10
    v_mfma_f32_16x16x32_f16 v[200:203], v[116:119], v[220:223], v[200:203]
    s_cselect_b32 s91, 10, 0
    s_sub_u32 s17, s17, s91
    v_mfma_f32_16x16x32_f16 v[204:207], v[148:151], v[220:223], v[204:207]
    s_lshl_b32 s17, s17, 12
    s_add_u32 s17, s17, s85
    v_mfma_f32_16x16x32_f16 v[208:211], v[180:183], v[220:223], v[208:211]
    s_add_u32 s18, s101, 9
    s_cmp_ge_u32 s18, 10
    s_waitcnt lgkmcnt(2)
    v_mfma_f32_16x16x32_f16 v[196:199], v[88:91], v[224:227], v[196:199]
    s_cselect_b32 s91, 10, 0
    s_sub_u32 s18, s18, s91
    v_mfma_f32_16x16x32_f16 v[200:203], v[120:123], v[224:227], v[200:203]
    s_lshl_b32 s18, s18, 12
    s_add_u32 s18, s18, s85
    v_mfma_f32_16x16x32_f16 v[204:207], v[152:155], v[224:227], v[204:207]
    s_mov_b32 s19, 10
    s_lshl_b32 s19, s19, 12
    v_mfma_f32_16x16x32_f16 v[208:211], v[184:187], v[224:227], v[208:211]
    s_add_u32 s19, s19, s85
    s_waitcnt lgkmcnt(1)
    v_mfma_f32_16x16x32_f16 v[196:199], v[92:95], v[228:231], v[196:199]
    v_mfma_f32_16x16x32_f16 v[200:203], v[124:127], v[228:231], v[200:203]
    v_mfma_f32_16x16x32_f16 v[204:207], v[156:159], v[228:231], v[204:207]
    v_mfma_f32_16x16x32_f16 v[208:211], v[188:191], v[228:231], v[208:211]
    s_waitcnt lgkmcnt(0)
    v_mfma_f32_16x16x32_f16 v[196:199], v[96:99], v[236:239], v[196:199]
    v_mfma_f32_16x16x32_f16 v[200:203], v[128:131], v[236:239], v[200:203]
    v_mfma_f32_16x16x32_f16 v[204:207], v[160:163], v[236:239], v[204:207]
    v_mfma_f32_16x16x32_f16 v[208:211], v[192:195], v[236:239], v[208:211]
    buffer_load_dwordx4 v[96:99], v2, s[52:55], s24 offen offset:0 sc1
    buffer_load_dwordx4 v[100:103], v2, s[52:55], s24 offen offset:1024 sc1
    buffer_load_dwordx4 v[104:107], v2, s[52:55], s24 offen offset:2048 sc1
    buffer_load_dwordx4 v[108:111], v2, s[52:55], s24 offen offset:3072 sc1
    buffer_load_dwordx4 v[112:115], v2, s[52:55], s25 offen offset:0 sc1
    buffer_load_dwordx4 v[116:119], v2, s[52:55], s25 offen offset:1024 sc1
    buffer_load_dwordx4 v[120:123], v2, s[52:55], s25 offen offset:2048 sc1
    buffer_load_dwordx4 v[124:127], v2, s[52:55], s25 offen offset:3072 sc1
    s_lshr_b32 s74, s60, 1
    s_add_u32 s74, s74, s71
    s_lshl_b32 s74, s74, 12
    s_add_u32 s74, s74, 5242880
    v_and_b32 v33, 15, v0
    v_lshrrev_b32 v34, 1, v33
    v_lshlrev_b32 v34, 6, v34
    v_and_b32 v33, 1, v33
    v_lshl_or_b32 v34, v33, 4, v34
    v_bfe_u32 v33, v0, 4, 1
    v_lshl_or_b32 v34, v33, 5, v34
    v_lshrrev_b32 v33, 5, v0
    v_lshl_or_b32 v249, v33, 9, v34
    v_mul_u32_u24 v33, 0x7fff, v33
    v_lshlrev_b32 v33, 16, v33
    v_or_b32 v250, v33, v249
    v_mov_b32 v34, 0x10001
    s_add_u32 s6, s74, 0
    s_add_u32 s7, s74, 1024
    s_add_u32 s8, s74, 2048
    v_mul_f32 v196, 0x3c000000, v196
    v_mul_f32 v197, 0x3c000000, v197
    v_mul_f32 v198, 0x3c000000, v198
    v_mul_f32 v199, 0x3c000000, v199
    v_cvt_pk_f16_f32 v216, v196, v197
    v_cvt_pk_f16_f32 v217, v198, v199
    v_bfi_b32 v216, v34, s11, v216
    v_bfi_b32 v217, v34, s11, v217
    v_mul_f32 v200, 0x3c000000, v200
    v_mul_f32 v201, 0x3c000000, v201
    v_mul_f32 v202, 0x3c000000, v202
    v_mul_f32 v203, 0x3c000000, v203
    v_cvt_pk_f16_f32 v218, v200, v201
    v_cvt_pk_f16_f32 v219, v202, v203
    v_bfi_b32 v218, v34, s11, v218
    v_bfi_b32 v219, v34, s11, v219
    v_mul_f32 v204, 0x3c000000, v204
    v_mul_f32 v205, 0x3c000000, v205
    v_mul_f32 v206, 0x3c000000, v206
    v_mul_f32 v207, 0x3c000000, v207
    v_cvt_pk_f16_f32 v220, v204, v205
    v_cvt_pk_f16_f32 v221, v206, v207
    v_bfi_b32 v220, v34, s11, v220
    v_bfi_b32 v221, v34, s11, v221
    v_mul_f32 v208, 0x3c000000, v208
    v_mul_f32 v209, 0x3c000000, v209
    v_mul_f32 v210, 0x3c000000, v210
    v_mul_f32 v211, 0x3c000000, v211
    v_cvt_pk_f16_f32 v222, v208, v209
    v_cvt_pk_f16_f32 v223, v210, v211
    v_bfi_b32 v222, v34, s11, v222
    v_bfi_b32 v223, v34, s11, v223
    v_mul_f32 v212, 0x3c000000, v212
    v_mul_f32 v213, 0x3c000000, v213
    v_mul_f32 v214, 0x3c000000, v214
    v_mul_f32 v215, 0x3c000000, v215
    v_cvt_pk_f16_f32 v224, v212, v213
    v_cvt_pk_f16_f32 v225, v214, v215
    v_bfi_b32 v224, v34, s11, v224
    v_bfi_b32 v225, v34, s11, v225
    v_permlane32_swap_b32 v216, v218
    v_permlane32_swap_b32 v217, v219
    v_permlane32_swap_b32 v220, v222
    v_permlane32_swap_b32 v221, v223
    v_permlane32_swap_b32 v224, v226
    v_permlane32_swap_b32 v225, v227
    s_waitcnt lgkmcnt(0)
    s_branch L_convE
L_convB:
    ds_read_b128 v[64:67], v8 offset:480
    ds_read_b128 v[68:71], v8 offset:992
    ds_read_b128 v[72:75], v8 offset:496
    ds_read_b128 v[76:79], v8 offset:1008
    ds_read_b128 v[80:83], v8 offset:1504
    ds_read_b128 v[84:87], v8 offset:2016
    ds_read_b128 v[88:91], v8 offset:1520
    ds_read_b128 v[92:95], v8 offset:2032
    s_waitcnt lgkmcnt(7)
    v_mfma_f32_16x16x32_f16 v[96:99], v[64:67], v[56:59], 0
    ds_read_b64 v[128:129], v10 offset:2240
    ds_read_b64 v[130:131], v10 offset:2272
    ds_read_b64 v[132:133], v10 offset:2448
    s_waitcnt lgkmcnt(9)
    v_mfma_f32_16x16x32_f16 v[100:103], v[68:71], v[56:59], 0
    ds_read_b64 v[134:135], v10 offset:2480
    ds_read_b64 v[136:137], v10 offset:2208
    ds_read_b64 v[138:139], v10 offset:2240
    s_waitcnt lgkmcnt(11)
    v_mfma_f32_16x16x32_f16 v[104:107], v[72:75], v[60:63], 0
    ds_read_b64 v[140:141], v10 offset:2416
    ds_read_b64 v[142:143], v10 offset:2448
    ds_read_b64 v[144:145], v10 offset:2272
    s_waitcnt lgkmcnt(13)
    v_mfma_f32_16x16x32_f16 v[108:111], v[76:79], v[60:63], 0
    ds_read_b64 v[146:147], v10 offset:2304
    ds_read_b64 v[148:149], v10 offset:2480
    ds_read_b64 v[150:151], v10 offset:2512
    s_waitcnt lgkmcnt(15)
    v_mfma_f32_16x16x32_f16 v[112:115], v[80:83], v[56:59], 0
    ds_read_b64 v[152:153], v10 offset:2176
    ds_read_b64 v[154:155], v10 offset:2208
    s_waitcnt lgkmcnt(15)
    v_mfma_f32_16x16x32_f16 v[116:119], v[84:87], v[56:59], 0
    ds_read_b64 v[156:157], v10 offset:2384
    ds_read_b64 v[158:159], v10 offset:2416
    v_mfma_f32_16x16x32_f16 v[120:123], v[88:91], v[60:63], 0
    ds_read_b64 v[160:161], v10 offset:2240
    ds_read_b64 v[162:163], v10 offset:2272
    s_waitcnt lgkmcnt(15)
    v_mfma_f32_16x16x32_f16 v[124:127], v[92:95], v[60:63], 0
    ds_read_b64 v[164:165], v10 offset:2448
    ds_read_b64 v[166:167], v10 offset:2480
    v_cvt_pk_f16_f32 v32, v96, v97
    v_cvt_pk_f16_f32 v33, v98, v99
    v_cvt_pk_f16_f32 v34, v100, v101
    v_cvt_pk_f16_f32 v35, v102, v103
    v_cvt_pk_f16_f32 v40, v104, v105
    v_cvt_pk_f16_f32 v41, v106, v107
    v_cvt_pk_f16_f32 v42, v108, v109
    v_cvt_pk_f16_f32 v43, v110, v111
    v_cvt_pk_f16_f32 v36, v112, v113
    v_cvt_pk_f16_f32 v37, v114, v115
    v_cvt_pk_f16_f32 v38, v116, v117
    v_cvt_pk_f16_f32 v39, v118, v119
    v_cvt_pk_f16_f32 v44, v120, v121
    v_cvt_pk_f16_f32 v45, v122, v123
    v_cvt_pk_f16_f32 v46, v124, v125
    v_cvt_pk_f16_f32 v47, v126, v127
    v_mfma_f32_16x16x32_f16 v[196:199], v[32:35], v[128:131], 0
    ds_read_b64 v[64:65], v9 offset:2048
    ds_read_b64 v[66:67], v9 offset:2056
    s_waitcnt lgkmcnt(15)
    v_mfma_f32_16x16x32_f16 v[196:199], v[40:43], v[132:135], v[196:199]
    ds_read_b128 v[216:219], v8 offset:4096
    ds_read_b64 v[68:69], v9 offset:1984
    v_mfma_f32_16x16x32_f16 v[200:203], v[32:35], v[136:139], 0
    ds_read_b64 v[70:71], v9 offset:1992
    ds_read_b128 v[220:223], v8 offset:4032
    s_waitcnt lgkmcnt(15)
    v_mfma_f32_16x16x32_f16 v[200:203], v[40:43], v[140:143], v[200:203]
    ds_read_b64 v[72:73], v9 offset:1920
    ds_read_b64 v[74:75], v9 offset:1928
    v_mfma_f32_16x16x32_f16 v[200:203], v[36:39], v[144:147], v[200:203]
    ds_read_b128 v[224:227], v8 offset:3968
    ds_read_b64 v[76:77], v9 offset:1856
    s_waitcnt lgkmcnt(15)
    v_mfma_f32_16x16x32_f16 v[200:203], v[44:47], v[148:151], v[200:203]
    ds_read_b64 v[78:79], v9 offset:1864
    v_mfma_f32_16x16x32_f16 v[204:207], v[32:35], v[152:155], 0
    ds_read_b128 v[228:231], v8 offset:3904
    s_waitcnt lgkmcnt(15)
    v_mfma_f32_16x16x32_f16 v[204:207], v[40:43], v[156:159], v[204:207]
    ds_read_b64 v[80:81], v9 offset:1792
    s_waitcnt lgkmcnt(15)
    v_mfma_f32_16x16x32_f16 v[204:207], v[36:39], v[160:163], v[204:207]
    ds_read_b64 v[82:83], v9 offset:1800
    s_waitcnt lgkmcnt(14)
    v_mfma_f32_16x16x32_f16 v[204:207], v[44:47], v[164:167], v[204:207]
    ds_read_b128 v[236:239], v8 offset:3840
    s_waitcnt lgkmcnt(12)
    v_mfma_f32_16x16x32_f16 v[204:207], v[64:67], v[216:219], v[204:207]
    ds_read_b64 v[84:85], v9 offset:1728
    ds_read_b64 v[86:87], v9 offset:1736
    ds_read_b128 v[240:243], v8 offset:3776
    s_waitcnt lgkmcnt(12)
    v_mfma_f32_16x16x32_f16 v[204:207], v[68:71], v[220:223], v[204:207]
    ds_read_b64 v[88:89], v9 offset:1664
    ds_read_b64 v[90:91], v9 offset:1672
    ds_read_b128 v[216:219], v8 offset:3712
    s_waitcnt lgkmcnt(12)
    v_mfma_f32_16x16x32_f16 v[204:207], v[72:75], v[224:227], v[204:207]
    ds_read_b64 v[92:93], v9 offset:1600
    ds_read_b64 v[94:95], v9 offset:1608
    ds_read_b128 v[220:223], v8 offset:3648
    s_waitcnt lgkmcnt(12)
    v_mfma_f32_16x16x32_f16 v[204:207], v[76:79], v[228:231], v[204:207]
    ds_read_b64 v[96:97], v9 offset:1536
    ds_read_b64 v[98:99], v9 offset:1544
    ds_read_b128 v[224:227], v8 offset:3584
    s_waitcnt lgkmcnt(12)
    v_mfma_f32_16x16x32_f16 v[204:207], v[80:83], v[236:239], v[204:207]
    ds_read_b64 v[100:101], v9 offset:1472
    ds_read_b64 v[102:103], v9 offset:1480
    ds_read_b128 v[228:231], v8 offset:3520
    s_waitcnt lgkmcnt(12)
    v_mfma_f32_16x16x32_f16 v[204:207], v[84:87], v[240:243], v[204:207]
    ds_read_b64 v[104:105], v9 offset:1408
    ds_read_b64 v[106:107], v9 offset:1416
    ds_read_b128 v[236:239], v8 offset:3456
    s_waitcnt lgkmcnt(12)
    v_mfma_f32_16x16x32_f16 v[204:207], v[88:91], v[216:219], v[204:207]
    ds_read_b64 v[108:109], v9 offset:1344
    ds_read_b64 v[110:111], v9 offset:1352
    ds_read_b128 v[240:243], v8 offset:3392
    s_waitcnt lgkmcnt(12)
    v_mfma_f32_16x16x32_f16 v[204:207], v[92:95], v[220:223], v[204:207]
    ds_read_b64 v[112:113], v9 offset:1280
    ds_read_b64 v[114:115], v9 offset:1288
    ds_read_b128 v[216:219], v8 offset:3328
    s_waitcnt lgkmcnt(12)
    v_mfma_f32_16x16x32_f16 v[200:203], v[64:67], v[224:227], v[200:203]
    ds_read_b64 v[116:117], v9 offset:1216
    ds_read_b64 v[118:119], v9 offset:1224
    v_mfma_f32_16x16x32_f16 v[204:207], v[96:99], v[224:227], v[204:207]
    ds_read_b128 v[220:223], v8 offset:3264
    s_waitcnt lgkmcnt(12)
    v_mfma_f32_16x16x32_f16 v[200:203], v[68:71], v[228:231], v[200:203]
    ds_read_b64 v[120:121], v9 offset:1152
    ds_read_b64 v[122:123], v9 offset:1160
    v_mfma_f32_16x16x32_f16 v[204:207], v[100:103], v[228:231], v[204:207]
    ds_read_b128 v[224:227], v8 offset:3200
    s_waitcnt lgkmcnt(12)
    v_mfma_f32_16x16x32_f16 v[200:203], v[72:75], v[236:239], v[200:203]
    ds_read_b64 v[124:125], v9 offset:1088
    ds_read_b64 v[126:127], v9 offset:1096
    v_mfma_f32_16x16x32_f16 v[204:207], v[104:107], v[236:239], v[204:207]
    ds_read_b128 v[228:231], v8 offset:3136
    s_waitcnt lgkmcnt(12)
    v_mfma_f32_16x16x32_f16 v[200:203], v[76:79], v[240:243], v[200:203]
    ds_read_b64 v[128:129], v9 offset:1024
    ds_read_b64 v[130:131], v9 offset:1032
    v_mfma_f32_16x16x32_f16 v[204:207], v[108:111], v[240:243], v[204:207]
    ds_read_b128 v[236:239], v8 offset:3072
    s_waitcnt lgkmcnt(12)
    v_mfma_f32_16x16x32_f16 v[200:203], v[80:83], v[216:219], v[200:203]
    ds_read_b64 v[132:133], v9 offset:960
    ds_read_b64 v[134:135], v9 offset:968
    v_mfma_f32_16x16x32_f16 v[204:207], v[112:115], v[216:219], v[204:207]
    ds_read_b128 v[240:243], v8 offset:3008
    s_waitcnt lgkmcnt(12)
    v_mfma_f32_16x16x32_f16 v[200:203], v[84:87], v[220:223], v[200:203]
    ds_read_b64 v[136:137], v9 offset:896
    ds_read_b64 v[138:139], v9 offset:904
    v_mfma_f32_16x16x32_f16 v[204:207], v[116:119], v[220:223], v[204:207]
    ds_read_b128 v[216:219], v8 offset:2944
    s_waitcnt lgkmcnt(12)
    v_mfma_f32_16x16x32_f16 v[200:203], v[88:91], v[224:227], v[200:203]
    ds_read_b64 v[140:141], v9 offset:832
    ds_read_b64 v[142:143], v9 offset:840
    v_mfma_f32_16x16x32_f16 v[204:207], v[120:123], v[224:227], v[204:207]
    ds_read_b128 v[220:223], v8 offset:2880
    s_waitcnt lgkmcnt(12)
    v_mfma_f32_16x16x32_f16 v[200:203], v[92:95], v[228:231], v[200:203]
    ds_read_b64 v[144:145], v9 offset:768
    ds_read_b64 v[146:147], v9 offset:776
    v_mfma_f32_16x16x32_f16 v[204:207], v[124:127], v[228:231], v[204:207]
    ds_read_b128 v[224:227], v8 offset:2816
    s_waitcnt lgkmcnt(12)
    v_mfma_f32_16x16x32_f16 v[196:199], v[64:67], v[236:239], v[196:199]
    ds_read_b64 v[148:149], v9 offset:704
    v_mfma_f32_16x16x32_f16 v[200:203], v[96:99], v[236:239], v[200:203]
    ds_read_b64 v[150:151], v9 offset:712
    v_mfma_f32_16x16x32_f16 v[204:207], v[128:131], v[236:239], v[204:207]
    ds_read_b128 v[228:231], v8 offset:2752
    s_waitcnt lgkmcnt(12)
    v_mfma_f32_16x16x32_f16 v[196:199], v[68:71], v[240:243], v[196:199]
    ds_read_b64 v[152:153], v9 offset:640
    v_mfma_f32_16x16x32_f16 v[200:203], v[100:103], v[240:243], v[200:203]
    ds_read_b64 v[154:155], v9 offset:648
    v_mfma_f32_16x16x32_f16 v[204:207], v[132:135], v[240:243], v[204:207]
    ds_read_b128 v[236:239], v8 offset:2688
    s_waitcnt lgkmcnt(12)
    v_mfma_f32_16x16x32_f16 v[196:199], v[72:75], v[216:219], v[196:199]
    ds_read_b64 v[156:157], v9 offset:576
    v_mfma_f32_16x16x32_f16 v[200:203], v[104:107], v[216:219], v[200:203]
    ds_read_b64 v[158:159], v9 offset:584
    v_mfma_f32_16x16x32_f16 v[204:207], v[136:139], v[216:219], v[204:207]
    ds_read_b128 v[240:243], v8 offset:2624
    s_waitcnt lgkmcnt(12)
    v_mfma_f32_16x16x32_f16 v[196:199], v[76:79], v[220:223], v[196:199]
    ds_read_b64 v[160:161], v9 offset:512
    v_mfma_f32_16x16x32_f16 v[200:203], v[108:111], v[220:223], v[200:203]
    ds_read_b64 v[162:163], v9 offset:520
    v_mfma_f32_16x16x32_f16 v[204:207], v[140:143], v[220:223], v[204:207]
    ds_read_b128 v[216:219], v8 offset:2560
    s_waitcnt lgkmcnt(12)
    v_mfma_f32_16x16x32_f16 v[196:199], v[80:83], v[224:227], v[196:199]
    ds_read_b64 v[164:165], v9 offset:448
    v_mfma_f32_16x16x32_f16 v[200:203], v[112:115], v[224:227], v[200:203]
    ds_read_b64 v[166:167], v9 offset:456
    v_mfma_f32_16x16x32_f16 v[204:207], v[144:147], v[224:227], v[204:207]
    ds_read_b128 v[220:223], v8 offset:2496
    s_waitcnt lgkmcnt(12)
    v_mfma_f32_16x16x32_f16 v[196:199], v[84:87], v[228:231], v[196:199]
    ds_read_b64 v[168:169], v9 offset:384
    v_mfma_f32_16x16x32_f16 v[200:203], v[116:119], v[228:231], v[200:203]
    ds_read_b64 v[170:171], v9 offset:392
    v_mfma_f32_16x16x32_f16 v[204:207], v[148:151], v[228:231], v[204:207]
    ds_read_b128 v[224:227], v8 offset:2432
    s_waitcnt lgkmcnt(12)
    v_mfma_f32_16x16x32_f16 v[196:199], v[88:91], v[236:239], v[196:199]
    ds_read_b64 v[172:173], v9 offset:320
    v_mfma_f32_16x16x32_f16 v[200:203], v[120:123], v[236:239], v[200:203]
    ds_read_b64 v[174:175], v9 offset:328
    v_mfma_f32_16x16x32_f16 v[204:207], v[152:155], v[236:239], v[204:207]
    ds_read_b128 v[228:231], v8 offset:2368
    s_waitcnt lgkmcnt(12)
    v_mfma_f32_16x16x32_f16 v[196:199], v[92:95], v[240:243], v[196:199]
    ds_read_b64 v[176:177], v9 offset:256
    v_mfma_f32_16x16x32_f16 v[200:203], v[124:127], v[240:243], v[200:203]
    ds_read_b64 v[178:179], v9 offset:264
    v_mfma_f32_16x16x32_f16 v[204:207], v[156:159], v[240:243], v[204:207]
    ds_read_b128 v[236:239], v8 offset:2304
    s_waitcnt lgkmcnt(12)
    v_mfma_f32_16x16x32_f16 v[196:199], v[96:99], v[216:219], v[196:199]
    ds_read_b64 v[180:181], v9 offset:192
    v_mfma_f32_16x16x32_f16 v[200:203], v[128:131], v[216:219], v[200:203]
    ds_read_b64 v[182:183], v9 offset:200
    v_mfma_f32_16x16x32_f16 v[204:207], v[160:163], v[216:219], v[204:207]
    ds_read_b128 v[240:243], v8 offset:2240
    s_waitcnt lgkmcnt(12)
    v_mfma_f32_16x16x32_f16 v[196:199], v[100:103], v[220:223], v[196:199]
    ds_read_b64 v[184:185], v9 offset:128
    v_mfma_f32_16x16x32_f16 v[200:203], v[132:135], v[220:223], v[200:203]
    ds_read_b64 v[186:187], v9 offset:136
    v_mfma_f32_16x16x32_f16 v[204:207], v[164:167], v[220:223], v[204:207]
    ds_read_b128 v[216:219], v8 offset:2176
    s_waitcnt lgkmcnt(12)
    v_mfma_f32_16x16x32_f16 v[196:199], v[104:107], v[224:227], v[196:199]
    ds_read_b64 v[188:189], v9 offset:64
    v_mfma_f32_16x16x32_f16 v[200:203], v[136:139], v[224:227], v[200:203]
    ds_read_b64 v[190:191], v9 offset:72
    v_mfma_f32_16x16x32_f16 v[204:207], v[168:171], v[224:227], v[204:207]
    ds_read_b128 v[220:223], v8 offset:2112
    s_waitcnt lgkmcnt(12)
    v_mfma_f32_16x16x32_f16 v[196:199], v[108:111], v[228:231], v[196:199]
    ds_read_b64 v[192:193], v9 offset:0
    v_mfma_f32_16x16x32_f16 v[200:203], v[140:143], v[228:231], v[200:203]
    ds_read_b64 v[194:195], v9 offset:8
    v_mfma_f32_16x16x32_f16 v[204:207], v[172:175], v[228:231], v[204:207]
    ds_read_b128 v[224:227], v8 offset:2048
    s_waitcnt lgkmcnt(12)
    v_mfma_f32_16x16x32_f16 v[196:199], v[112:115], v[236:239], v[196:199]
    ds_read_b128 v[228:231], v8 offset:1984
    v_mfma_f32_16x16x32_f16 v[200:203], v[144:147], v[236:239], v[200:203]
    v_mfma_f32_16x16x32_f16 v[204:207], v[176:179], v[236:239], v[204:207]
    s_waitcnt lgkmcnt(10)
    v_mfma_f32_16x16x32_f16 v[196:199], v[116:119], v[240:243], v[196:199]
    ds_read_b128 v[236:239], v8 offset:1920
    s_lshr_b32 s74, s60, 1
    s_and_b32 s75, s60, 1
    v_mfma_f32_16x16x32_f16 v[200:203], v[148:151], v[240:243], v[200:203]
    s_lshr_b32 s76, s72, 5
    s_add_u32 s76, s76, s75
    s_mul_i32 s76, s76, 86
    v_mfma_f32_16x16x32_f16 v[204:207], v[180:183], v[240:243], v[204:207]
    s_mul_i32 s77, s74, 43
    s_add_u32 s76, s76, s77
    s_waitcnt lgkmcnt(8)
    v_mfma_f32_16x16x32_f16 v[196:199], v[120:123], v[216:219], v[196:199]
    ds_read_b128 v[240:243], v8 offset:1856
    s_lshl_b32 s76, s76, 10
    s_add_u32 s85, s76, 9437184
    v_mfma_f32_16x16x32_f16 v[200:203], v[152:155], v[216:219], v[200:203]
    v_lshrrev_b32 v33, 5, v0
    v_lshlrev_b32 v33, 3, v33
    v_bfe_u32 v34, v0, 2, 2
    v_mfma_f32_16x16x32_f16 v[204:207], v[184:187], v[216:219], v[204:207]
    v_add_u32 v33, v33, v34
    v_lshlrev_b32 v33, 7, v33
    s_waitcnt lgkmcnt(6)
    v_mfma_f32_16x16x32_f16 v[196:199], v[124:127], v[220:223], v[196:199]
    ds_read_b128 v[216:219], v8 offset:1792
    v_bfe_u32 v34, v0, 4, 1
    v_lshlrev_b32 v34, 1, v34
    v_mfma_f32_16x16x32_f16 v[200:203], v[156:159], v[220:223], v[200:203]
    v_bfe_u32 v35, v0, 1, 1
    v_add_u32 v34, v34, v35
    s_lshl_b32 s77, s74, 2
    v_mfma_f32_16x16x32_f16 v[204:207], v[188:191], v[220:223], v[204:207]
    v_or_b32 v34, s77, v34
    v_bfe_u32 v35, v0, 3, 1
    s_waitcnt lgkmcnt(4)
    v_mfma_f32_16x16x32_f16 v[196:199], v[128:131], v[224:227], v[196:199]
    ds_read_b128 v[220:223], v8 offset:1728
    v_lshlrev_b32 v35, 2, v35
    v_xor_b32 v34, v34, v35
    v_mfma_f32_16x16x32_f16 v[200:203], v[160:163], v[224:227], v[200:203]
    v_lshl_add_u32 v33, v34, 4, v33
    v_and_b32 v34, 1, v0
    v_mfma_f32_16x16x32_f16 v[204:207], v[192:195], v[224:227], v[204:207]
    v_lshl_add_u32 v33, v34, 3, v33
    s_lshl_b32 s77, s74, 13
    s_waitcnt lgkmcnt(4)
    v_mfma_f32_16x16x32_f16 v[196:199], v[132:135], v[228:231], v[196:199]
    ds_read_b128 v[224:227], v8 offset:1664
    v_add_u32 v24, s77, v33
    v_xor_b32 v25, 64, v24
    s_mov_b32 s12, 49152
    v_mfma_f32_16x16x32_f16 v[200:203], v[164:167], v[228:231], v[200:203]
    v_add_u32 v26, 65536, v24
    v_add_u32 v27, 65536, v25
    v_add_u32 v36, 114688, v24
    s_waitcnt lgkmcnt(4)
    v_mfma_f32_16x16x32_f16 v[196:199], v[136:139], v[236:239], v[196:199]
    ds_read_b128 v[228:231], v8 offset:1600
    v_add_u32 v37, 114688, v25
    s_lshr_b32 s74, s60, 1
    s_lshl_b32 s74, s74, 5
    v_mfma_f32_16x16x32_f16 v[200:203], v[168:171], v[236:239], v[200:203]
    s_add_u32 s74, s74, s73
    v_and_b32 v28, 31, v0
    v_add_u32 v28, s74, v28
    s_waitcnt lgkmcnt(4)
    v_mfma_f32_16x16x32_f16 v[196:199], v[140:143], v[240:243], v[196:199]
    ds_read_b128 v[236:239], v8 offset:1536
    v_lshlrev_b32 v29, 3, v28
    v_lshlrev_b32 v28, 12, v28
    v_lshrrev_b32 v31, 5, v0
    v_mfma_f32_16x16x32_f16 v[200:203], v[172:175], v[240:243], v[200:203]
    v_lshl_add_u32 v28, v31, 5, v28
    s_and_b32 s75, s60, 1
    s_lshl_b32 s75, s75, 5
    s_waitcnt lgkmcnt(4)
    v_mfma_f32_16x16x32_f16 v[196:199], v[144:147], v[216:219], v[196:199]
    ds_read_b128 v[240:243], v8 offset:1472
    s_add_u32 s75, s75, s72
    s_lshl_b32 s75, s75, 1
    s_add_u32 s80, s75, 5242880
    v_mfma_f32_16x16x32_f16 v[200:203], v[176:179], v[216:219], v[200:203]
    s_add_u32 s24, s101, 0
    s_cmp_ge_u32 s24, 10
    s_cselect_b32 s91, 10, 0
    s_waitcnt lgkmcnt(4)
    v_mfma_f32_16x16x32_f16 v[196:199], v[148:151], v[220:223], v[196:199]
    ds_read_b128 v[216:219], v8 offset:1408
    s_sub_u32 s24, s24, s91
    s_lshl_b32 s24, s24, 12
    s_add_u32 s24, s24, s85
    v_mfma_f32_16x16x32_f16 v[200:203], v[180:183], v[220:223], v[200:203]
    s_add_u32 s25, s101, 1
    s_cmp_ge_u32 s25, 10
    s_cselect_b32 s91, 10, 0
    s_waitcnt lgkmcnt(4)
    v_mfma_f32_16x16x32_f16 v[196:199], v[152:155], v[224:227], v[196:199]
    ds_read_b128 v[220:223], v8 offset:1344
    s_sub_u32 s25, s25, s91
    s_lshl_b32 s25, s25, 12
    s_add_u32 s25, s25, s85
    v_mfma_f32_16x16x32_f16 v[200:203], v[184:187], v[224:227], v[200:203]
    s_add_u32 s26, s101, 2
    s_cmp_ge_u32 s26, 10
    s_cselect_b32 s91, 10, 0
    s_waitcnt lgkmcnt(4)
    v_mfma_f32_16x16x32_f16 v[196:199], v[156:159], v[228:231], v[196:199]
    ds_read_b128 v[224:227], v8 offset:1280
    s_sub_u32 s26, s26, s91
    s_lshl_b32 s26, s26, 12
    s_add_u32 s26, s26, s85
    v_mfma_f32_16x16x32_f16 v[200:203], v[188:191], v[228:231], v[200:203]
    s_add_u32 s27, s101, 3
    s_cmp_ge_u32 s27, 10
    s_cselect_b32 s91, 10, 0
    s_waitcnt lgkmcnt(4)
    v_mfma_f32_16x16x32_f16 v[196:199], v[160:163], v[236:239], v[196:199]
    ds_read_b128 v[228:231], v8 offset:1216
    s_sub_u32 s27, s27, s91
    s_lshl_b32 s27, s27, 12
    s_add_u32 s27, s27, s85
    v_mfma_f32_16x16x32_f16 v[200:203], v[192:195], v[236:239], v[200:203]
    s_add_u32 s13, s101, 4
    s_cmp_ge_u32 s13, 10
    s_cselect_b32 s91, 10, 0
    s_waitcnt lgkmcnt(4)
    v_mfma_f32_16x16x32_f16 v[196:199], v[164:167], v[240:243], v[196:199]
    ds_read_b128 v[236:239], v8 offset:1152
    s_sub_u32 s13, s13, s91
    s_lshl_b32 s13, s13, 12
    s_add_u32 s13, s13, s85
    s_add_u32 s14, s101, 5
    s_cmp_ge_u32 s14, 10
    s_cselect_b32 s91, 10, 0
    s_waitcnt lgkmcnt(4)
    v_mfma_f32_16x16x32_f16 v[196:199], v[168:171], v[216:219], v[196:199]
    ds_read_b128 v[240:243], v8 offset:1088
    s_sub_u32 s14, s14, s91
    s_lshl_b32 s14, s14, 12
    s_add_u32 s14, s14, s85
    s_add_u32 s15, s101, 6
    s_cmp_ge_u32 s15, 10
    s_cselect_b32 s91, 10, 0
    s_waitcnt lgkmcnt(4)
    v_mfma_f32_16x16x32_f16 v[196:199], v[172:175], v[220:223], v[196:199]
    ds_read_b128 v[216:219], v8 offset:1024
    s_sub_u32 s15, s15, s91
    s_lshl_b32 s15, s15, 12
    s_add_u32 s15, s15, s85
    s_add_u32 s16, s101, 7
    s_cmp_ge_u32 s16, 10
    s_cselect_b32 s91, 10, 0
    s_waitcnt lgkmcnt(4)
    v_mfma_f32_16x16x32_f16 v[196:199], v[176:179], v[224:227], v[196:199]
    s_sub_u32 s16, s16, s91
    s_lshl_b32 s16, s16, 12
    s_add_u32 s16, s16, s85
    s_add_u32 s17, s101, 8
    s_cmp_ge_u32 s17, 10
    s_cselect_b32 s91, 10, 0
    s_waitcnt lgkmcnt(3)
    v_mfma_f32_16x16x32_f16 v[196:199], v[180:183], v[228:231], v[196:199]
    s_sub_u32 s17, s17, s91
    s_lshl_b32 s17, s17, 12
    s_add_u32 s17, s17, s85
    s_add_u32 s18, s101, 9
    s_cmp_ge_u32 s18, 10
    s_cselect_b32 s91, 10, 0
    s_waitcnt lgkmcnt(2)
    v_mfma_f32_16x16x32_f16 v[196:199], v[184:187], v[236:239], v[196:199]
    s_sub_u32 s18, s18, s91
    s_lshl_b32 s18, s18, 12
    s_add_u32 s18, s18, s85
    s_mov_b32 s19, 10
    s_lshl_b32 s19, s19, 12
    s_add_u32 s19, s19, s85
    s_waitcnt lgkmcnt(1)
    v_mfma_f32_16x16x32_f16 v[196:199], v[188:191], v[240:243], v[196:199]
    s_waitcnt lgkmcnt(0)
    v_mfma_f32_16x16x32_f16 v[196:199], v[192:195], v[216:219], v[196:199]
    buffer_load_dwordx4 v[96:99], v2, s[52:55], s24 offen offset:0 sc1
    buffer_load_dwordx4 v[100:103], v2, s[52:55], s24 offen offset:1024 sc1
    buffer_load_dwordx4 v[104:107], v2, s[52:55], s24 offen offset:2048 sc1
    buffer_load_dwordx4 v[108:111], v2, s[52:55], s24 offen offset:3072 sc1
    buffer_load_dwordx4 v[112:115], v2, s[52:55], s25 offen offset:0 sc1
    buffer_load_dwordx4 v[116:119], v2, s[52:55], s25 offen offset:1024 sc1
    buffer_load_dwordx4 v[120:123], v2, s[52:55], s25 offen offset:2048 sc1
    buffer_load_dwordx4 v[124:127], v2, s[52:55], s25 offen offset:3072 sc1
    s_lshr_b32 s74, s60, 1
    s_add_u32 s74, s74, s71
    s_lshl_b32 s74, s74, 12
    s_add_u32 s74, s74, 5242880
    v_and_b32 v33, 15, v0
    v_lshrrev_b32 v34, 1, v33
    v_lshlrev_b32 v34, 6, v34
    v_and_b32 v33, 1, v33
    v_lshl_or_b32 v34, v33, 4, v34
    v_bfe_u32 v33, v0, 4, 1
    v_lshl_or_b32 v34, v33, 5, v34
    v_lshrrev_b32 v33, 5, v0
    v_lshl_or_b32 v249, v33, 9, v34
    v_mul_u32_u24 v33, 0x7fff, v33
    v_lshlrev_b32 v33, 16, v33
    v_or_b32 v250, v33, v249
    v_mov_b32 v34, 0x10001
    s_add_u32 s6, s74, 2560
    s_add_u32 s7, s74, 3584
    s_mov_b32 s8, 2147418112
    s_mov_b32 s8, s7
    s_mov_b32 s7, 2147418112
    v_mul_f32 v196, 0x3c000000, v196
    v_mul_f32 v197, 0x3c000000, v197
    v_mul_f32 v198, 0x3c000000, v198
    v_mul_f32 v199, 0x3c000000, v199
    v_cvt_pk_f16_f32 v216, v196, v197
    v_cvt_pk_f16_f32 v217, v198, v199
    v_bfi_b32 v216, v34, s11, v216
    v_bfi_b32 v217, v34, s11, v217
    v_mul_f32 v200, 0x3c000000, v200
    v_mul_f32 v201, 0x3c000000, v201
    v_mul_f32 v202, 0x3c000000, v202
    v_mul_f32 v203, 0x3c000000, v203
    v_cvt_pk_f16_f32 v218, v200, v201
    v_cvt_pk_f16_f32 v219, v202, v203
    v_bfi_b32 v218, v34, s11, v218
    v_bfi_b32 v219, v34, s11, v219
    v_mul_f32 v204, 0x3c000000, v204
    v_mul_f32 v205, 0x3c000000, v205
    v_mul_f32 v206, 0x3c000000, v206
    v_mul_f32 v207, 0x3c000000, v207
    v_cvt_pk_f16_f32 v224, v204, v205
    v_cvt_pk_f16_f32 v225, v206, v207
    v_bfi_b32 v224, v34, s11, v224
    v_bfi_b32 v225, v34, s11, v225
    v_permlane32_swap_b32 v216, v218
    v_permlane32_swap_b32 v217, v219
    v_permlane32_swap_b32 v224, v226
    v_permlane32_swap_b32 v225, v227
    s_waitcnt lgkmcnt(0)
L_convE:
    s_barrier
    buffer_load_dwordx4 v[128:131], v2, s[52:55], s26 offen offset:0 sc1
    buffer_load_dwordx4 v[132:135], v2, s[52:55], s26 offen offset:1024 sc1
    buffer_load_dwordx4 v[136:139], v2, s[52:55], s26 offen offset:2048 sc1
    buffer_load_dwordx4 v[140:143], v2, s[52:55], s26 offen offset:3072 sc1
    buffer_load_dwordx4 v[144:147], v2, s[52:55], s27 offen offset:0 sc1
    buffer_load_dwordx4 v[148:151], v2, s[52:55], s27 offen offset:1024 sc1
    buffer_load_dwordx4 v[152:155], v2, s[52:55], s27 offen offset:2048 sc1
    buffer_load_dwordx4 v[156:159], v2, s[52:55], s27 offen offset:3072 sc1
    ds_read_b64_tr_b16 v[160:161], v24 offset:0
    ds_read_b64_tr_b16 v[162:163], v24 offset:512
    ds_read_b64_tr_b16 v[164:165], v25 offset:0
    ds_read_b64_tr_b16 v[166:167], v25 offset:512
    ds_read_b64_tr_b16 v[168:169], v24 offset:2048
    ds_read_b64_tr_b16 v[170:171], v24 offset:2560
    ds_read_b64_tr_b16 v[172:173], v25 offset:2048
    ds_read_b64_tr_b16 v[174:175], v25 offset:2560
    s_waitcnt vmcnt(12)
    v_xor_b32 v96, s4, v96
    v_xor_b32 v97, s4, v97
    v_xor_b32 v98, s4, v98
    v_xor_b32 v99, s4, v99
    v_xor_b32 v100, s4, v100
    v_xor_b32 v101, s4, v101
    v_xor_b32 v102, s4, v102
    v_xor_b32 v103, s4, v103
    v_xor_b32 v104, s4, v104
    v_xor_b32 v105, s4, v105
    v_xor_b32 v106, s4, v106
    v_xor_b32 v107, s4, v107
    v_xor_b32 v108, s4, v108
    v_xor_b32 v109, s4, v109
    v_xor_b32 v110, s4, v110
    v_xor_b32 v111, s4, v111
    v_or3_b32 v33, v96, v97, v98
    v_or3_b32 v33, v33, v99, v100
    v_or3_b32 v33, v33, v101, v102
    v_or3_b32 v33, v33, v103, v104
    v_or3_b32 v33, v33, v105, v106
    v_or3_b32 v33, v33, v107, v108
    v_or3_b32 v33, v33, v109, v110
    v_or_b32 v33, v33, v111
    v_and_b32 v33, 0x80008000, v33
    v_cmp_ne_u32 vcc, 0, v33
    s_nop 4
    s_cbranch_vccnz L_hr0
L_hb0:
    s_waitcnt vmcnt(11) lgkmcnt(4)
    v_mfma_f32_32x32x16_bf16 v[64:79], v[96:99], v[160:163], 0
    v_xor_b32 v112, s4, v112
    v_xor_b32 v113, s4, v113
    v_xor_b32 v114, s4, v114
    v_xor_b32 v115, s4, v115
    v_or3_b32 v33, v112, v113, v114
    v_mfma_f32_32x32x16_bf16 v[80:95], v[96:99], v[164:167], 0
    v_or_b32 v33, v33, v115
    ds_read_b64_tr_b16 v[176:177], v24 offset:4096
    ds_read_b64_tr_b16 v[178:179], v24 offset:4608
    ds_read_b64_tr_b16 v[180:181], v25 offset:4096
    ds_read_b64_tr_b16 v[182:183], v25 offset:4608
    buffer_load_dwordx4 v[96:99], v2, s[52:55], s13 offen offset:0 sc1
    s_waitcnt vmcnt(11) lgkmcnt(4)
    v_mfma_f32_32x32x16_bf16 v[64:79], v[100:103], v[168:171], v[64:79]
    v_xor_b32 v116, s4, v116
    v_xor_b32 v117, s4, v117
    v_xor_b32 v118, s4, v118
    v_xor_b32 v119, s4, v119
    v_or3_b32 v33, v33, v116, v117
    v_mfma_f32_32x32x16_bf16 v[80:95], v[100:103], v[172:175], v[80:95]
    v_or3_b32 v33, v33, v118, v119
    ds_read_b64_tr_b16 v[160:161], v24 offset:6144
    ds_read_b64_tr_b16 v[162:163], v24 offset:6656
    ds_read_b64_tr_b16 v[164:165], v25 offset:6144
    ds_read_b64_tr_b16 v[166:167], v25 offset:6656
    buffer_load_dwordx4 v[100:103], v2, s[52:55], s13 offen offset:1024 sc1
    buffer_store_dwordx4 v[216:219], v249, s[52:55], s6 offen sc1
    s_waitcnt vmcnt(12) lgkmcnt(4)
    v_mfma_f32_32x32x16_bf16 v[64:79], v[104:107], v[176:179], v[64:79]
    v_xor_b32 v120, s4, v120
    v_xor_b32 v121, s4, v121
    v_xor_b32 v122, s4, v122
    v_xor_b32 v123, s4, v123
    v_or3_b32 v33, v33, v120, v121
    v_mfma_f32_32x32x16_bf16 v[80:95], v[104:107], v[180:183], v[80:95]
    v_or3_b32 v33, v33, v122, v123
    ds_read_b64_tr_b16 v[168:169], v24 offset:16384
    ds_read_b64_tr_b16 v[170:171], v24 offset:16896
    ds_read_b64_tr_b16 v[172:173], v25 offset:16384
    ds_read_b64_tr_b16 v[174:175], v25 offset:16896
    buffer_load_dwordx4 v[104:107], v2, s[52:55], s13 offen offset:2048 sc1
    buffer_store_dwordx4 v[220:223], v249, s[52:55], s7 offen sc1
    s_waitcnt vmcnt(13) lgkmcnt(4)
    v_mfma_f32_32x32x16_bf16 v[64:79], v[108:111], v[160:163], v[64:79]
    v_xor_b32 v124, s4, v124
    v_xor_b32 v125, s4, v125
    v_xor_b32 v126, s4, v126
    v_xor_b32 v127, s4, v127
    v_or3_b32 v33, v33, v124, v125
    v_or3_b32 v33, v33, v126, v127
    v_mfma_f32_32x32x16_bf16 v[80:95], v[108:111], v[164:167], v[80:95]
    v_and_b32 v33, 0x80008000, v33
    v_cmp_ne_u32 vcc, 0, v33
    ds_read_b64_tr_b16 v[176:177], v24 offset:18432
    ds_read_b64_tr_b16 v[178:179], v24 offset:18944
    ds_read_b64_tr_b16 v[180:181], v25 offset:18432
    ds_read_b64_tr_b16 v[182:183], v25 offset:18944
    buffer_load_dwordx4 v[108:111], v2, s[52:55], s13 offen offset:3072 sc1
    buffer_store_dwordx4 v[224:227], v250, s[52:55], s8 offen sc1
    s_cbranch_vccnz L_hr1
L_hb1:
    s_waitcnt vmcnt(14) lgkmcnt(4)
    v_mfma_f32_32x32x16_bf16 v[64:79], v[112:115], v[168:171], v[64:79]
    v_xor_b32 v128, s4, v128
    v_xor_b32 v129, s4, v129
    v_xor_b32 v130, s4, v130
    v_xor_b32 v131, s4, v131
    v_or3_b32 v33, v128, v129, v130
    v_mfma_f32_32x32x16_bf16 v[80:95], v[112:115], v[172:175], v[80:95]
    v_or_b32 v33, v33, v131
    ds_read_b64_tr_b16 v[160:161], v24 offset:20480
    ds_read_b64_tr_b16 v[162:163], v24 offset:20992
    ds_read_b64_tr_b16 v[164:165], v25 offset:20480
    ds_read_b64_tr_b16 v[166:167], v25 offset:20992
    buffer_load_dwordx4 v[112:115], v2, s[52:55], s14 offen offset:0 sc1
    s_waitcnt vmcnt(14) lgkmcnt(4)
    v_mfma_f32_32x32x16_bf16 v[64:79], v[116:119], v[176:179], v[64:79]
    v_xor_b32 v132, s4, v132
    v_xor_b32 v133, s4, v133
    v_xor_b32 v134, s4, v134
    v_xor_b32 v135, s4, v135
    v_or3_b32 v33, v33, v132, v133
    v_mfma_f32_32x32x16_bf16 v[80:95], v[116:119], v[180:183], v[80:95]
    v_or3_b32 v33, v33, v134, v135
    ds_read_b64_tr_b16 v[168:169], v24 offset:22528
    ds_read_b64_tr_b16 v[170:171], v24 offset:23040
    ds_read_b64_tr_b16 v[172:173], v25 offset:22528
    ds_read_b64_tr_b16 v[174:175], v25 offset:23040
    buffer_load_dwordx4 v[116:119], v2, s[52:55], s14 offen offset:1024 sc1
    s_barrier
    s_waitcnt vmcnt(14) lgkmcnt(4)
    v_mfma_f32_32x32x16_bf16 v[64:79], v[120:123], v[160:163], v[64:79]
    v_xor_b32 v136, s4, v136
    v_xor_b32 v137, s4, v137
    v_xor_b32 v138, s4, v138
    v_xor_b32 v139, s4, v139
    v_or3_b32 v33, v33, v136, v137
    v_mfma_f32_32x32x16_bf16 v[80:95], v[120:123], v[164:167], v[80:95]
    v_or3_b32 v33, v33, v138, v139
    ds_read_b64_tr_b16 v[176:177], v24 offset:32768
    ds_read_b64_tr_b16 v[178:179], v24 offset:33280
    ds_read_b64_tr_b16 v[180:181], v25 offset:32768
    ds_read_b64_tr_b16 v[182:183], v25 offset:33280
    buffer_load_dwordx4 v[120:123], v2, s[52:55], s14 offen offset:2048 sc1
    s_waitcnt vmcnt(14) lgkmcnt(4)
    v_mfma_f32_32x32x16_bf16 v[64:79], v[124:127], v[168:171], v[64:79]
    v_xor_b32 v140, s4, v140
    v_xor_b32 v141, s4, v141
    v_xor_b32 v142, s4, v142
    v_xor_b32 v143, s4, v143
    v_or3_b32 v33, v33, v140, v141
    v_or3_b32 v33, v33, v142, v143
    v_mfma_f32_32x32x16_bf16 v[80:95], v[124:127], v[172:175], v[80:95]
    v_and_b32 v33, 0x80008000, v33
    v_cmp_ne_u32 vcc, 0, v33
    ds_read_b64_tr_b16 v[160:161], v24 offset:34816
    ds_read_b64_tr_b16 v[162:163], v24 offset:35328
    ds_read_b64_tr_b16 v[164:165], v25 offset:34816
    ds_read_b64_tr_b16 v[166:167], v25 offset:35328
    buffer_load_dwordx4 v[124:127], v2, s[52:55], s14 offen offset:3072 sc1
    s_cbranch_vccnz L_hr2
L_hb2:
    s_waitcnt vmcnt(14) lgkmcnt(4)
    v_mfma_f32_32x32x16_bf16 v[64:79], v[128:131], v[176:179], v[64:79]
    v_xor_b32 v144, s4, v144
    v_xor_b32 v145, s4, v145
    v_xor_b32 v146, s4, v146
    v_xor_b32 v147, s4, v147
    v_or3_b32 v33, v144, v145, v146
    v_mfma_f32_32x32x16_bf16 v[80:95], v[128:131], v[180:183], v[80:95]
    v_or_b32 v33, v33, v147
    ds_read_b64_tr_b16 v[168:169], v24 offset:36864
    ds_read_b64_tr_b16 v[170:171], v24 offset:37376
    ds_read_b64_tr_b16 v[172:173], v25 offset:36864
    ds_read_b64_tr_b16 v[174:175], v25 offset:37376
    buffer_load_dwordx4 v[128:131], v2, s[52:55], s15 offen offset:0 sc1
    s_waitcnt vmcnt(14) lgkmcnt(4)
    v_mfma_f32_32x32x16_bf16 v[64:79], v[132:135], v[160:163], v[64:79]
    v_xor_b32 v148, s4, v148
    v_xor_b32 v149, s4, v149
    v_xor_b32 v150, s4, v150
    v_xor_b32 v151, s4, v151
    v_or3_b32 v33, v33, v148, v149
    v_mfma_f32_32x32x16_bf16 v[80:95], v[132:135], v[164:167], v[80:95]
    v_or3_b32 v33, v33, v150, v151
    ds_read_b64_tr_b16 v[176:177], v24 offset:38912
    ds_read_b64_tr_b16 v[178:179], v24 offset:39424
    ds_read_b64_tr_b16 v[180:181], v25 offset:38912
    ds_read_b64_tr_b16 v[182:183], v25 offset:39424
    buffer_load_dwordx4 v[132:135], v2, s[52:55], s15 offen offset:1024 sc1
    s_barrier
    s_waitcnt vmcnt(14) lgkmcnt(4)
    v_mfma_f32_32x32x16_bf16 v[64:79], v[136:139], v[168:171], v[64:79]
    v_xor_b32 v152, s4, v152
    v_xor_b32 v153, s4, v153
    v_xor_b32 v154, s4, v154
    v_xor_b32 v155, s4, v155
    v_or3_b32 v33, v33, v152, v153
    v_mfma_f32_32x32x16_bf16 v[80:95], v[136:139], v[172:175], v[80:95]
    v_or3_b32 v33, v33, v154, v155
    ds_read_b64_tr_b16 v[160:161], v24 offset:49152
    ds_read_b64_tr_b16 v[162:163], v24 offset:49664
    ds_read_b64_tr_b16 v[164:165], v25 offset:49152
    ds_read_b64_tr_b16 v[166:167], v25 offset:49664
    buffer_load_dwordx4 v[136:139], v2, s[52:55], s15 offen offset:2048 sc1
    s_waitcnt vmcnt(14) lgkmcnt(4)
    v_mfma_f32_32x32x16_bf16 v[64:79], v[140:143], v[176:179], v[64:79]
    v_xor_b32 v156, s4, v156
    v_xor_b32 v157, s4, v157
    v_xor_b32 v158, s4, v158
    v_xor_b32 v159, s4, v159
    v_or3_b32 v33, v33, v156, v157
    v_or3_b32 v33, v33, v158, v159
    v_mfma_f32_32x32x16_bf16 v[80:95], v[140:143], v[180:183], v[80:95]
    v_and_b32 v33, 0x80008000, v33
    v_cmp_ne_u32 vcc, 0, v33
    ds_read_b64_tr_b16 v[168:169], v24 offset:51200
    ds_read_b64_tr_b16 v[170:171], v24 offset:51712
    ds_read_b64_tr_b16 v[172:173], v25 offset:51200
    ds_read_b64_tr_b16 v[174:175], v25 offset:51712
    buffer_load_dwordx4 v[140:143], v2, s[52:55], s15 offen offset:3072 sc1
    s_cbranch_vccnz L_hr3
L_hb3:
    s_waitcnt vmcnt(14) lgkmcnt(4)
    v_mfma_f32_32x32x16_bf16 v[64:79], v[144:147], v[160:163], v[64:79]
    v_xor_b32 v96, s4, v96
    v_xor_b32 v97, s4, v97
    v_xor_b32 v98, s4, v98
    v_xor_b32 v99, s4, v99
    v_or3_b32 v33, v96, v97, v98
    v_mfma_f32_32x32x16_bf16 v[80:95], v[144:147], v[164:167], v[80:95]
    v_or_b32 v33, v33, v99
    ds_read_b64_tr_b16 v[176:177], v24 offset:53248
    ds_read_b64_tr_b16 v[178:179], v24 offset:53760
    ds_read_b64_tr_b16 v[180:181], v25 offset:53248
    ds_read_b64_tr_b16 v[182:183], v25 offset:53760
    buffer_load_dwordx4 v[144:147], v2, s[52:55], s16 offen offset:0 sc1
    s_waitcnt vmcnt(14) lgkmcnt(4)
    v_mfma_f32_32x32x16_bf16 v[64:79], v[148:151], v[168:171], v[64:79]
    v_xor_b32 v100, s4, v100
    v_xor_b32 v101, s4, v101
    v_xor_b32 v102, s4, v102
    v_xor_b32 v103, s4, v103
    v_or3_b32 v33, v33, v100, v101
    v_mfma_f32_32x32x16_bf16 v[80:95], v[148:151], v[172:175], v[80:95]
    v_or3_b32 v33, v33, v102, v103
    ds_read_b64_tr_b16 v[160:161], v24 offset:55296
    ds_read_b64_tr_b16 v[162:163], v24 offset:55808
    ds_read_b64_tr_b16 v[164:165], v25 offset:55296
    ds_read_b64_tr_b16 v[166:167], v25 offset:55808
    buffer_load_dwordx4 v[148:151], v2, s[52:55], s16 offen offset:1024 sc1
    s_waitcnt vmcnt(13) lgkmcnt(4)
    v_mfma_f32_32x32x16_bf16 v[64:79], v[152:155], v[176:179], v[64:79]
    v_xor_b32 v104, s4, v104
    v_xor_b32 v105, s4, v105
    v_xor_b32 v106, s4, v106
    v_xor_b32 v107, s4, v107
    v_or3_b32 v33, v33, v104, v105
    v_mfma_f32_32x32x16_bf16 v[80:95], v[152:155], v[180:183], v[80:95]
    v_or3_b32 v33, v33, v106, v107
    ds_read_b64_tr_b16 v[168:169], v26 offset:0
    ds_read_b64_tr_b16 v[170:171], v26 offset:512
    ds_read_b64_tr_b16 v[172:173], v27 offset:0
    ds_read_b64_tr_b16 v[174:175], v27 offset:512
    buffer_load_dwordx4 v[152:155], v2, s[52:55], s16 offen offset:2048 sc1
    s_waitcnt vmcnt(12) lgkmcnt(4)
    v_mfma_f32_32x32x16_bf16 v[64:79], v[156:159], v[160:163], v[64:79]
    v_xor_b32 v108, s4, v108
    v_xor_b32 v109, s4, v109
    v_xor_b32 v110, s4, v110
    v_xor_b32 v111, s4, v111
    v_or3_b32 v33, v33, v108, v109
    v_or3_b32 v33, v33, v110, v111
    v_mfma_f32_32x32x16_bf16 v[80:95], v[156:159], v[164:167], v[80:95]
    v_and_b32 v33, 0x80008000, v33
    v_cmp_ne_u32 vcc, 0, v33
    ds_read_b64_tr_b16 v[176:177], v26 offset:2048
    ds_read_b64_tr_b16 v[178:179], v26 offset:2560
    ds_read_b64_tr_b16 v[180:181], v27 offset:2048
    ds_read_b64_tr_b16 v[182:183], v27 offset:2560
    buffer_load_dwordx4 v[156:159], v2, s[52:55], s16 offen offset:3072 sc1
    s_cbranch_vccnz L_hr4
L_hb4:
    s_waitcnt vmcnt(11) lgkmcnt(4)
    v_mfma_f32_32x32x16_bf16 v[64:79], v[96:99], v[168:171], v[64:79]
    v_xor_b32 v112, s4, v112
    v_xor_b32 v113, s4, v113
    v_xor_b32 v114, s4, v114
    v_xor_b32 v115, s4, v115
    v_or3_b32 v33, v112, v113, v114
    v_mfma_f32_32x32x16_bf16 v[80:95], v[96:99], v[172:175], v[80:95]
    v_or_b32 v33, v33, v115
    ds_read_b64_tr_b16 v[160:161], v26 offset:4096
    ds_read_b64_tr_b16 v[162:163], v26 offset:4608
    ds_read_b64_tr_b16 v[164:165], v27 offset:4096
    ds_read_b64_tr_b16 v[166:167], v27 offset:4608
    buffer_load_dwordx4 v[96:99], v2, s[52:55], s17 offen offset:0 sc1
    s_waitcnt vmcnt(11) lgkmcnt(4)
    v_mfma_f32_32x32x16_bf16 v[64:79], v[100:103], v[176:179], v[64:79]
    v_xor_b32 v116, s4, v116
    v_xor_b32 v117, s4, v117
    v_xor_b32 v118, s4, v118
    v_xor_b32 v119, s4, v119
    v_or3_b32 v33, v33, v116, v117
    v_mfma_f32_32x32x16_bf16 v[80:95], v[100:103], v[180:183], v[80:95]
    v_or3_b32 v33, v33, v118, v119
    ds_read_b64_tr_b16 v[168:169], v26 offset:6144
    ds_read_b64_tr_b16 v[170:171], v26 offset:6656
    ds_read_b64_tr_b16 v[172:173], v27 offset:6144
    ds_read_b64_tr_b16 v[174:175], v27 offset:6656
    buffer_load_dwordx4 v[100:103], v2, s[52:55], s17 offen offset:1024 sc1
    s_waitcnt vmcnt(11) lgkmcnt(4)
    v_mfma_f32_32x32x16_bf16 v[64:79], v[104:107], v[160:163], v[64:79]
    v_xor_b32 v120, s4, v120
    v_xor_b32 v121, s4, v121
    v_xor_b32 v122, s4, v122
    v_xor_b32 v123, s4, v123
    v_or3_b32 v33, v33, v120, v121
    v_mfma_f32_32x32x16_bf16 v[80:95], v[104:107], v[164:167], v[80:95]
    v_or3_b32 v33, v33, v122, v123
    ds_read_b64_tr_b16 v[176:177], v26 offset:16384
    ds_read_b64_tr_b16 v[178:179], v26 offset:16896
    ds_read_b64_tr_b16 v[180:181], v27 offset:16384
    ds_read_b64_tr_b16 v[182:183], v27 offset:16896
    buffer_load_dwordx4 v[104:107], v2, s[52:55], s17 offen offset:2048 sc1
    s_waitcnt vmcnt(11) lgkmcnt(4)
    v_mfma_f32_32x32x16_bf16 v[64:79], v[108:111], v[168:171], v[64:79]
    v_xor_b32 v124, s4, v124
    v_xor_b32 v125, s4, v125
    v_xor_b32 v126, s4, v126
    v_xor_b32 v127, s4, v127
    v_or3_b32 v33, v33, v124, v125
    v_or3_b32 v33, v33, v126, v127
    v_mfma_f32_32x32x16_bf16 v[80:95], v[108:111], v[172:175], v[80:95]
    v_and_b32 v33, 0x80008000, v33
    v_cmp_ne_u32 vcc, 0, v33
    ds_read_b64_tr_b16 v[160:161], v26 offset:18432
    ds_read_b64_tr_b16 v[162:163], v26 offset:18944
    ds_read_b64_tr_b16 v[164:165], v27 offset:18432
    ds_read_b64_tr_b16 v[166:167], v27 offset:18944
    buffer_load_dwordx4 v[108:111], v2, s[52:55], s17 offen offset:3072 sc1
    s_cbranch_vccnz L_hr5
L_hb5:
    s_waitcnt vmcnt(11) lgkmcnt(4)
    v_mfma_f32_32x32x16_bf16 v[64:79], v[112:115], v[176:179], v[64:79]
    v_xor_b32 v128, s4, v128
    v_xor_b32 v129, s4, v129
    v_xor_b32 v130, s4, v130
    v_xor_b32 v131, s4, v131
    v_or3_b32 v33, v128, v129, v130
    v_mfma_f32_32x32x16_bf16 v[80:95], v[112:115], v[180:183], v[80:95]
    v_or_b32 v33, v33, v131
    ds_read_b64_tr_b16 v[168:169], v26 offset:20480
    ds_read_b64_tr_b16 v[170:171], v26 offset:20992
    ds_read_b64_tr_b16 v[172:173], v27 offset:20480
    ds_read_b64_tr_b16 v[174:175], v27 offset:20992
    buffer_load_dwordx4 v[112:115], v2, s[52:55], s18 offen offset:0 sc1
    s_waitcnt vmcnt(11) lgkmcnt(4)
    v_mfma_f32_32x32x16_bf16 v[64:79], v[116:119], v[160:163], v[64:79]
    v_xor_b32 v132, s4, v132
    v_xor_b32 v133, s4, v133
    v_xor_b32 v134, s4, v134
    v_xor_b32 v135, s4, v135
    v_or3_b32 v33, v33, v132, v133
    v_mfma_f32_32x32x16_bf16 v[80:95], v[116:119], v[164:167], v[80:95]
    v_or3_b32 v33, v33, v134, v135
    ds_read_b64_tr_b16 v[176:177], v26 offset:22528
    ds_read_b64_tr_b16 v[178:179], v26 offset:23040
    ds_read_b64_tr_b16 v[180:181], v27 offset:22528
    ds_read_b64_tr_b16 v[182:183], v27 offset:23040
    buffer_load_dwordx4 v[116:119], v2, s[52:55], s18 offen offset:1024 sc1
    s_waitcnt vmcnt(11) lgkmcnt(4)
    v_mfma_f32_32x32x16_bf16 v[64:79], v[120:123], v[168:171], v[64:79]
    v_xor_b32 v136, s4, v136
    v_xor_b32 v137, s4, v137
    v_xor_b32 v138, s4, v138
    v_xor_b32 v139, s4, v139
    v_or3_b32 v33, v33, v136, v137
    v_mfma_f32_32x32x16_bf16 v[80:95], v[120:123], v[172:175], v[80:95]
    v_or3_b32 v33, v33, v138, v139
    ds_read_b64_tr_b16 v[160:161], v26 offset:32768
    ds_read_b64_tr_b16 v[162:163], v26 offset:33280
    ds_read_b64_tr_b16 v[164:165], v27 offset:32768
    ds_read_b64_tr_b16 v[166:167], v27 offset:33280
    buffer_load_dwordx4 v[120:123], v2, s[52:55], s18 offen offset:2048 sc1
    s_waitcnt vmcnt(11) lgkmcnt(4)
    v_mfma_f32_32x32x16_bf16 v[64:79], v[124:127], v[176:179], v[64:79]
    v_xor_b32 v140, s4, v140
    v_xor_b32 v141, s4, v141
    v_xor_b32 v142, s4, v142
    v_xor_b32 v143, s4, v143
    v_or3_b32 v33, v33, v140, v141
    v_or3_b32 v33, v33, v142, v143
    v_mfma_f32_32x32x16_bf16 v[80:95], v[124:127], v[180:183], v[80:95]
    v_and_b32 v33, 0x80008000, v33
    v_cmp_ne_u32 vcc, 0, v33
    ds_read_b64_tr_b16 v[168:169], v26 offset:34816
    ds_read_b64_tr_b16 v[170:171], v26 offset:35328
    ds_read_b64_tr_b16 v[172:173], v27 offset:34816
    ds_read_b64_tr_b16 v[174:175], v27 offset:35328
    buffer_load_dwordx4 v[124:127], v2, s[52:55], s18 offen offset:3072 sc1
    s_cbranch_vccnz L_hr6
L_hb6:
    s_waitcnt vmcnt(11) lgkmcnt(4)
    v_mfma_f32_32x32x16_bf16 v[64:79], v[128:131], v[160:163], v[64:79]
    v_xor_b32 v144, s4, v144
    v_xor_b32 v145, s4, v145
    v_xor_b32 v146, s4, v146
    v_xor_b32 v147, s4, v147
    v_or3_b32 v33, v144, v145, v146
    v_mfma_f32_32x32x16_bf16 v[80:95], v[128:131], v[164:167], v[80:95]
    v_or_b32 v33, v33, v147
    ds_read_b64_tr_b16 v[176:177], v26 offset:36864
    ds_read_b64_tr_b16 v[178:179], v26 offset:37376
    ds_read_b64_tr_b16 v[180:181], v27 offset:36864
    ds_read_b64_tr_b16 v[182:183], v27 offset:37376
    buffer_load_dwordx4 v[128:131], v2, s[52:55], s19 offen offset:0 sc1
    s_waitcnt vmcnt(11) lgkmcnt(4)
    v_mfma_f32_32x32x16_bf16 v[64:79], v[132:135], v[168:171], v[64:79]
    v_xor_b32 v148, s4, v148
    v_xor_b32 v149, s4, v149
    v_xor_b32 v150, s4, v150
    v_xor_b32 v151, s4, v151
    v_or3_b32 v33, v33, v148, v149
    v_mfma_f32_32x32x16_bf16 v[80:95], v[132:135], v[172:175], v[80:95]
    v_or3_b32 v33, v33, v150, v151
    ds_read_b64_tr_b16 v[160:161], v26 offset:38912
    ds_read_b64_tr_b16 v[162:163], v26 offset:39424
    ds_read_b64_tr_b16 v[164:165], v27 offset:38912
    ds_read_b64_tr_b16 v[166:167], v27 offset:39424
    buffer_load_dwordx4 v[132:135], v2, s[52:55], s19 offen offset:1024 sc1
    s_waitcnt vmcnt(11) lgkmcnt(4)
    v_mfma_f32_32x32x16_bf16 v[64:79], v[136:139], v[176:179], v[64:79]
    v_xor_b32 v152, s4, v152
    v_xor_b32 v153, s4, v153
    v_xor_b32 v154, s4, v154
    v_xor_b32 v155, s4, v155
    v_or3_b32 v33, v33, v152, v153
    v_mfma_f32_32x32x16_bf16 v[80:95], v[136:139], v[180:183], v[80:95]
    v_or3_b32 v33, v33, v154, v155
    ds_read_b64_tr_b16 v[168:169], v36 offset:20992
    ds_read_b64_tr_b16 v[170:171], v36 offset:21504
    ds_read_b64_tr_b16 v[172:173], v37 offset:20992
    ds_read_b64_tr_b16 v[174:175], v37 offset:21504
    buffer_load_dwordx4 v[136:139], v2, s[52:55], s19 offen offset:2048 sc1
    s_waitcnt vmcnt(11) lgkmcnt(4)
    v_mfma_f32_32x32x16_bf16 v[64:79], v[140:143], v[160:163], v[64:79]
    v_xor_b32 v156, s4, v156
    v_xor_b32 v157, s4, v157
    v_xor_b32 v158, s4, v158
    v_xor_b32 v159, s4, v159
    v_or3_b32 v33, v33, v156, v157
    v_or3_b32 v33, v33, v158, v159
    v_mfma_f32_32x32x16_bf16 v[80:95], v[140:143], v[164:167], v[80:95]
    v_and_b32 v33, 0x80008000, v33
    v_cmp_ne_u32 vcc, 0, v33
    ds_read_b64_tr_b16 v[176:177], v36 offset:23040
    ds_read_b64_tr_b16 v[178:179], v36 offset:23552
    ds_read_b64_tr_b16 v[180:181], v37 offset:23040
    ds_read_b64_tr_b16 v[182:183], v37 offset:23552
    buffer_load_dwordx4 v[192:195], v28, s[52:55], s80 offen sc1
    buffer_load_dwordx4 v[196:199], v28, s[52:55], s80 offen offset:16 sc1
    buffer_load_dwordx2 v[200:201], v29, s[52:55], s12 offen sc1
    s_cbranch_vccnz L_hr7
L_hb7:
    s_waitcnt vmcnt(13) lgkmcnt(4)
    v_mfma_f32_32x32x16_bf16 v[64:79], v[144:147], v[168:171], v[64:79]
    v_xor_b32 v96, s4, v96
    v_xor_b32 v97, s4, v97
    v_xor_b32 v98, s4, v98
    v_xor_b32 v99, s4, v99
    v_or3_b32 v33, v96, v97, v98
    v_mfma_f32_32x32x16_bf16 v[80:95], v[144:147], v[172:175], v[80:95]
    v_or_b32 v33, v33, v99
    ds_read_b64_tr_b16 v[160:161], v36 offset:25088
    ds_read_b64_tr_b16 v[162:163], v36 offset:25600
    ds_read_b64_tr_b16 v[164:165], v37 offset:25088
    ds_read_b64_tr_b16 v[166:167], v37 offset:25600
    s_waitcnt vmcnt(12) lgkmcnt(4)
    v_mfma_f32_32x32x16_bf16 v[64:79], v[148:151], v[176:179], v[64:79]
    v_xor_b32 v100, s4, v100
    v_xor_b32 v101, s4, v101
    v_xor_b32 v102, s4, v102
    v_xor_b32 v103, s4, v103
    v_or3_b32 v33, v33, v100, v101
    v_mfma_f32_32x32x16_bf16 v[80:95], v[148:151], v[180:183], v[80:95]
    v_or3_b32 v33, v33, v102, v103
    ds_read_b64_tr_b16 v[168:169], v36 offset:27136
    ds_read_b64_tr_b16 v[170:171], v36 offset:27648
    ds_read_b64_tr_b16 v[172:173], v37 offset:27136
    ds_read_b64_tr_b16 v[174:175], v37 offset:27648
    s_barrier
    s_waitcnt vmcnt(11) lgkmcnt(4)
    v_mfma_f32_32x32x16_bf16 v[64:79], v[152:155], v[160:163], v[64:79]
    v_xor_b32 v104, s4, v104
    v_xor_b32 v105, s4, v105
    v_xor_b32 v106, s4, v106
    v_xor_b32 v107, s4, v107
    v_or3_b32 v33, v33, v104, v105
    v_mfma_f32_32x32x16_bf16 v[80:95], v[152:155], v[164:167], v[80:95]
    v_or3_b32 v33, v33, v106, v107
    ds_read_b64_tr_b16 v[176:177], v36 offset:0
    ds_read_b64_tr_b16 v[178:179], v36 offset:512
    ds_read_b64_tr_b16 v[180:181], v37 offset:0
    ds_read_b64_tr_b16 v[182:183], v37 offset:512
    s_waitcnt vmcnt(10) lgkmcnt(4)
    v_mfma_f32_32x32x16_bf16 v[64:79], v[156:159], v[168:171], v[64:79]
    v_xor_b32 v108, s4, v108
    v_xor_b32 v109, s4, v109
    v_xor_b32 v110, s4, v110
    v_xor_b32 v111, s4, v111
    v_or3_b32 v33, v33, v108, v109
    v_or3_b32 v33, v33, v110, v111
    v_mfma_f32_32x32x16_bf16 v[80:95], v[156:159], v[172:175], v[80:95]
    v_and_b32 v33, 0x80008000, v33
    v_cmp_ne_u32 vcc, 0, v33
    ds_read_b64_tr_b16 v[160:161], v36 offset:2048
    ds_read_b64_tr_b16 v[162:163], v36 offset:2560
    ds_read_b64_tr_b16 v[164:165], v37 offset:2048
    ds_read_b64_tr_b16 v[166:167], v37 offset:2560
    s_nop 0
    s_cbranch_vccnz L_hr8
L_hb8:
    s_waitcnt vmcnt(9) lgkmcnt(4)
    v_mfma_f32_32x32x16_bf16 v[64:79], v[96:99], v[176:179], v[64:79]
    v_xor_b32 v112, s4, v112
    v_xor_b32 v113, s4, v113
    v_xor_b32 v114, s4, v114
    v_xor_b32 v115, s4, v115
    v_or3_b32 v33, v112, v113, v114
    v_mfma_f32_32x32x16_bf16 v[80:95], v[96:99], v[180:183], v[80:95]
    v_or_b32 v33, v33, v115
    ds_read_b64_tr_b16 v[168:169], v36 offset:4096
    ds_read_b64_tr_b16 v[170:171], v36 offset:4608
    ds_read_b64_tr_b16 v[172:173], v37 offset:4096
    ds_read_b64_tr_b16 v[174:175], v37 offset:4608
    s_waitcnt vmcnt(8) lgkmcnt(4)
    v_mfma_f32_32x32x16_bf16 v[64:79], v[100:103], v[160:163], v[64:79]
    v_xor_b32 v116, s4, v116
    v_xor_b32 v117, s4, v117
    v_xor_b32 v118, s4, v118
    v_xor_b32 v119, s4, v119
    v_or3_b32 v33, v33, v116, v117
    v_mfma_f32_32x32x16_bf16 v[80:95], v[100:103], v[164:167], v[80:95]
    v_or3_b32 v33, v33, v118, v119
    ds_read_b64_tr_b16 v[176:177], v36 offset:6144
    ds_read_b64_tr_b16 v[178:179], v36 offset:6656
    ds_read_b64_tr_b16 v[180:181], v37 offset:6144
    ds_read_b64_tr_b16 v[182:183], v37 offset:6656
    s_waitcnt vmcnt(7) lgkmcnt(4)
    v_mfma_f32_32x32x16_bf16 v[64:79], v[104:107], v[168:171], v[64:79]
    v_xor_b32 v120, s4, v120
    v_xor_b32 v121, s4, v121
    v_xor_b32 v122, s4, v122
    v_xor_b32 v123, s4, v123
    v_or3_b32 v33, v33, v120, v121
    v_mfma_f32_32x32x16_bf16 v[80:95], v[104:107], v[172:175], v[80:95]
    v_or3_b32 v33, v33, v122, v123
    ds_read_b64_tr_b16 v[160:161], v24 offset:0
    ds_read_b64_tr_b16 v[162:163], v24 offset:512
    ds_read_b64_tr_b16 v[164:165], v25 offset:0
    ds_read_b64_tr_b16 v[166:167], v25 offset:512
    s_waitcnt vmcnt(6) lgkmcnt(4)
    v_mfma_f32_32x32x16_bf16 v[64:79], v[108:111], v[176:179], v[64:79]
    v_xor_b32 v124, s4, v124
    v_xor_b32 v125, s4, v125
    v_xor_b32 v126, s4, v126
    v_xor_b32 v127, s4, v127
    v_or3_b32 v33, v33, v124, v125
    v_or3_b32 v33, v33, v126, v127
    v_mfma_f32_32x32x16_bf16 v[80:95], v[108:111], v[180:183], v[80:95]
    v_and_b32 v33, 0x80008000, v33
    v_cmp_ne_u32 vcc, 0, v33
    ds_read_b64_tr_b16 v[168:169], v24 offset:2048
    ds_read_b64_tr_b16 v[170:171], v24 offset:2560
    ds_read_b64_tr_b16 v[172:173], v25 offset:2048
    ds_read_b64_tr_b16 v[174:175], v25 offset:2560
    s_nop 0
    s_cbranch_vccnz L_hr9
L_hb9:
    s_waitcnt vmcnt(5) lgkmcnt(4)
    v_mfma_f32_32x32x16_bf16 v[64:79], v[112:115], v[160:163], v[64:79]
    v_xor_b32 v128, s4, v128
    v_xor_b32 v129, s4, v129
    v_xor_b32 v130, s4, v130
    v_xor_b32 v131, s4, v131
    v_or3_b32 v33, v128, v129, v130
    v_mfma_f32_32x32x16_bf16 v[80:95], v[112:115], v[164:167], v[80:95]
    v_or_b32 v33, v33, v131
    ds_read_b64_tr_b16 v[176:177], v24 offset:4096
    ds_read_b64_tr_b16 v[178:179], v24 offset:4608
    ds_read_b64_tr_b16 v[180:181], v25 offset:4096
    ds_read_b64_tr_b16 v[182:183], v25 offset:4608
    s_waitcnt vmcnt(4) lgkmcnt(4)
    v_mfma_f32_32x32x16_bf16 v[64:79], v[116:119], v[168:171], v[64:79]
    v_xor_b32 v132, s4, v132
    v_xor_b32 v133, s4, v133
    v_xor_b32 v134, s4, v134
    v_xor_b32 v135, s4, v135
    v_or3_b32 v33, v33, v132, v133
    v_mfma_f32_32x32x16_bf16 v[80:95], v[116:119], v[172:175], v[80:95]
    v_or3_b32 v33, v33, v134, v135
    ds_read_b64_tr_b16 v[160:161], v24 offset:6144
    ds_read_b64_tr_b16 v[162:163], v24 offset:6656
    ds_read_b64_tr_b16 v[164:165], v25 offset:6144
    ds_read_b64_tr_b16 v[166:167], v25 offset:6656
    s_waitcnt vmcnt(3) lgkmcnt(4)
    v_mfma_f32_32x32x16_bf16 v[64:79], v[120:123], v[176:179], v[64:79]
    v_xor_b32 v136, s4, v136
    v_xor_b32 v137, s4, v137
    v_xor_b32 v138, s4, v138
    v_xor_b32 v139, s4, v139
    v_or3_b32 v33, v33, v136, v137
    v_mfma_f32_32x32x16_bf16 v[80:95], v[120:123], v[180:183], v[80:95]
    v_or3_b32 v33, v33, v138, v139
    ds_read_b64_tr_b16 v[168:169], v24 offset:16384
    ds_read_b64_tr_b16 v[170:171], v24 offset:16896
    ds_read_b64_tr_b16 v[172:173], v25 offset:16384
    ds_read_b64_tr_b16 v[174:175], v25 offset:16896
    s_waitcnt lgkmcnt(4)
    v_mfma_f32_32x32x16_bf16 v[64:79], v[124:127], v[160:163], v[64:79]
    v_and_b32 v33, 0x80008000, v33
    v_cmp_ne_u32 vcc, 0, v33
    ds_read_b64_tr_b16 v[176:177], v24 offset:18432
    v_mfma_f32_32x32x16_bf16 v[80:95], v[124:127], v[164:167], v[80:95]
    ds_read_b64_tr_b16 v[178:179], v24 offset:18944
    ds_read_b64_tr_b16 v[180:181], v25 offset:18432
    ds_read_b64_tr_b16 v[182:183], v25 offset:18944
    s_cbranch_vccnz L_hr10
L_hb10:
    s_waitcnt lgkmcnt(4)
    v_mfma_f32_32x32x16_bf16 v[64:79], v[128:131], v[168:171], v[64:79]
    ds_read_b64_tr_b16 v[160:161], v24 offset:20480
    ds_read_b64_tr_b16 v[162:163], v24 offset:20992
    v_mfma_f32_32x32x16_bf16 v[80:95], v[128:131], v[172:175], v[80:95]
    ds_read_b64_tr_b16 v[164:165], v25 offset:20480
    ds_read_b64_tr_b16 v[166:167], v25 offset:20992
    s_waitcnt lgkmcnt(4)
    v_mfma_f32_32x32x16_bf16 v[64:79], v[132:135], v[176:179], v[64:79]
    v_mfma_f32_32x32x16_bf16 v[80:95], v[132:135], v[180:183], v[80:95]
    s_waitcnt vmcnt(0)
    s_mov_b32 s87, 0
L_y_chk:
    v_bitop3_b32 v34, s11, v192, v193 bitop3:0x7e
    v_bitop3_b32 v35, s11, v194, v195 bitop3:0x7e
    v_or_b32 v36, v34, v35
    v_bitop3_b32 v34, s11, v196, v197 bitop3:0x7e
    v_bitop3_b32 v35, s11, v198, v199 bitop3:0x7e
    v_or3_b32 v36, v36, v34, v35
    v_and_b32 v36, 0x10001, v36
    v_xor_b32 v34, s63, v201
    v_or_b32 v36, v36, v34
    v_cmp_ne_u32 vcc, 0, v36
    s_nop 4
    s_cbranch_vccz L_y_ok
    s_add_u32 s87, s87, 1
    s_cmp_ge_u32 s87, 4096
    s_cbranch_scc1 L_y_ok
    buffer_load_dwordx4 v[192:195], v28, s[52:55], s80 offen sc1
    buffer_load_dwordx4 v[196:199], v28, s[52:55], s80 offen offset:16 sc1
    buffer_load_dwordx2 v[200:201], v29, s[52:55], s12 offen sc1
    s_waitcnt vmcnt(0)
    s_branch L_y_chk
L_y_ok:
    v_and_b32 v192, 0xfffefffe, v192
    v_and_b32 v193, 0xfffefffe, v193
    v_and_b32 v194, 0xfffefffe, v194
    v_and_b32 v195, 0xfffefffe, v195
    v_and_b32 v196, 0xfffefffe, v196
    v_and_b32 v197, 0xfffefffe, v197
    v_and_b32 v198, 0xfffefffe, v198
    v_and_b32 v199, 0xfffefffe, v199
    s_waitcnt lgkmcnt(0)
    v_mfma_f32_32x32x16_bf16 v[64:79], v[136:139], v[160:163], v[64:79]
    v_mfma_f32_32x32x16_bf16 v[80:95], v[136:139], v[164:167], v[80:95]
    v_lshlrev_b32 v248, 16, v248
    s_and_b32 s74, s60, 1
    s_mul_i32 s74, s74, 8704
    s_lshr_b32 s75, s60, 1
    s_lshl_b32 s76, s75, 7
    s_add_u32 s76, s76, s74
    s_add_u32 s76, s76, 49152
    s_xor_b32 s75, s75, 1
    s_lshl_b32 s75, s75, 7
    s_add_u32 s75, s75, s74
    s_add_u32 s75, s75, 66560
    v_lshrrev_b32 v37, 5, v0
    v_mul_u32_u24 v37, 1088, v37
    v_and_b32 v34, 31, v0
    v_lshl_add_u32 v37, v34, 2, v37
    v_add_u32 v36, s75, v37
    v_add_u32 v37, s76, v37
    v_add_f32 v64, v64, v248
    v_fma_mix_f32 v64, v192, v200, v64 op_sel:[0,0,0] op_sel_hi:[1,0,0]
    ds_write_b32 v36, v80 offset:0
    v_add_f32 v65, v65, v248
    v_fma_mix_f32 v65, v192, v200, v65 op_sel:[1,0,0] op_sel_hi:[1,0,0]
    ds_write_b32 v36, v81 offset:272
    v_add_f32 v66, v66, v248
    v_fma_mix_f32 v66, v193, v200, v66 op_sel:[0,0,0] op_sel_hi:[1,0,0]
    ds_write_b32 v36, v82 offset:544
    v_add_f32 v67, v67, v248
    v_fma_mix_f32 v67, v193, v200, v67 op_sel:[1,0,0] op_sel_hi:[1,0,0]
    ds_write_b32 v36, v83 offset:816
    v_add_f32 v68, v68, v248
    v_fma_mix_f32 v68, v194, v200, v68 op_sel:[0,0,0] op_sel_hi:[1,0,0]
    ds_write_b32 v36, v84 offset:2176
    v_add_f32 v69, v69, v248
    v_fma_mix_f32 v69, v194, v200, v69 op_sel:[1,0,0] op_sel_hi:[1,0,0]
    ds_write_b32 v36, v85 offset:2448
    v_add_f32 v70, v70, v248
    v_fma_mix_f32 v70, v195, v200, v70 op_sel:[0,0,0] op_sel_hi:[1,0,0]
    ds_write_b32 v36, v86 offset:2720
    v_add_f32 v71, v71, v248
    v_fma_mix_f32 v71, v195, v200, v71 op_sel:[1,0,0] op_sel_hi:[1,0,0]
    ds_write_b32 v36, v87 offset:2992
    v_add_f32 v72, v72, v248
    v_fma_mix_f32 v72, v196, v200, v72 op_sel:[0,0,0] op_sel_hi:[1,0,0]
    ds_write_b32 v36, v88 offset:4352
    v_add_f32 v73, v73, v248
    v_fma_mix_f32 v73, v196, v200, v73 op_sel:[1,0,0] op_sel_hi:[1,0,0]
    ds_write_b32 v36, v89 offset:4624
    v_add_f32 v74, v74, v248
    v_fma_mix_f32 v74, v197, v200, v74 op_sel:[0,0,0] op_sel_hi:[1,0,0]
    ds_write_b32 v36, v90 offset:4896
    v_add_f32 v75, v75, v248
    v_fma_mix_f32 v75, v197, v200, v75 op_sel:[1,0,0] op_sel_hi:[1,0,0]
    ds_write_b32 v36, v91 offset:5168
    v_add_f32 v76, v76, v248
    v_fma_mix_f32 v76, v198, v200, v76 op_sel:[0,0,0] op_sel_hi:[1,0,0]
    ds_write_b32 v36, v92 offset:6528
    v_add_f32 v77, v77, v248
    v_fma_mix_f32 v77, v198, v200, v77 op_sel:[1,0,0] op_sel_hi:[1,0,0]
    ds_write_b32 v36, v93 offset:6800
    v_add_f32 v78, v78, v248
    v_fma_mix_f32 v78, v199, v200, v78 op_sel:[0,0,0] op_sel_hi:[1,0,0]
    ds_write_b32 v36, v94 offset:7072
    v_add_f32 v79, v79, v248
    v_fma_mix_f32 v79, v199, v200, v79 op_sel:[1,0,0] op_sel_hi:[1,0,0]
    ds_write_b32 v36, v95 offset:7344
    ds_write_b32 v37, v64 offset:0
    ds_write_b32 v37, v65 offset:272
    ds_write_b32 v37, v66 offset:544
    ds_write_b32 v37, v67 offset:816
    ds_write_b32 v37, v68 offset:2176
    ds_write_b32 v37, v69 offset:2448
    ds_write_b32 v37, v70 offset:2720
    ds_write_b32 v37, v71 offset:2992
    ds_write_b32 v37, v72 offset:4352
    ds_write_b32 v37, v73 offset:4624
    ds_write_b32 v37, v74 offset:4896
    ds_write_b32 v37, v75 offset:5168
    ds_write_b32 v37, v76 offset:6528
    ds_write_b32 v37, v77 offset:6800
    ds_write_b32 v37, v78 offset:7072
    ds_write_b32 v37, v79 offset:7344
    s_waitcnt lgkmcnt(0)
    v_lshrrev_b32 v33, 3, v1
    v_mul_u32_u24 v33, 272, v33
    v_and_b32 v34, 7, v1
    v_lshl_add_u32 v33, v34, 5, v33
    v_add_u32 v33, 49152, v33
    v_lshlrev_b32 v48, 16, v232
    v_and_b32 v49, 0xffff0000, v232
    v_lshlrev_b32 v50, 16, v233
    v_and_b32 v51, 0xffff0000, v233
    v_lshlrev_b32 v52, 16, v234
    v_and_b32 v53, 0xffff0000, v234
    v_lshlrev_b32 v54, 16, v235
    v_and_b32 v55, 0xffff0000, v235
    s_barrier
    ds_read_b128 v[40:43], v33
    ds_read_b128 v[44:47], v33 offset:16
    ds_read_b128 v[56:59], v33 offset:17408
    ds_read_b128 v[60:63], v33 offset:17424
    s_waitcnt lgkmcnt(0)
    v_add_f32 v40, v40, v56
    v_add_f32 v41, v41, v57
    v_add_f32 v42, v42, v58
    v_add_f32 v43, v43, v59
    v_add_f32 v44, v44, v60
    v_add_f32 v45, v45, v61
    v_add_f32 v46, v46, v62
    v_add_f32 v47, v47, v63
    v_add_f32 v40, v40, v48
    v_add_f32 v41, v41, v49
    v_add_f32 v42, v42, v50
    v_add_f32 v43, v43, v51
    v_add_f32 v44, v44, v52
    v_add_f32 v45, v45, v53
    v_add_f32 v46, v46, v54
    v_add_f32 v47, v47, v55
    v_cvt_pk_bf16_f32 v48, v40, v41
    v_cvt_pk_bf16_f32 v49, v42, v43
    v_cvt_pk_bf16_f32 v50, v44, v45
    v_cvt_pk_bf16_f32 v51, v46, v47
    buffer_store_dwordx4 v[48:51], v30, s[56:59], 0 offen sc1 nt
    s_or_b32 s74, s2, s60
    s_cmp_eq_u32 s74, 0
    s_cbranch_scc0 L_end
    v_mov_b32 v33, s63
    s_mov_b64 exec, 1
    buffer_store_dword v33, off, s[52:55], 0 sc1
    s_branch L_end
L_hr0:
    s_mov_b32 s87, 0
L_hr0_again:
    s_add_u32 s79, s101, 0
    s_cmp_ge_u32 s79, 10
    s_cselect_b32 s91, 10, 0
    s_sub_u32 s79, s79, s91
    s_lshl_b32 s79, s79, 12
    s_add_u32 s79, s79, s85
    buffer_load_dwordx4 v[96:99], v2, s[52:55], s79 offen offset:0 sc1
    buffer_load_dwordx4 v[100:103], v2, s[52:55], s79 offen offset:1024 sc1
    buffer_load_dwordx4 v[104:107], v2, s[52:55], s79 offen offset:2048 sc1
    buffer_load_dwordx4 v[108:111], v2, s[52:55], s79 offen offset:3072 sc1
    s_waitcnt vmcnt(0)
    v_xor_b32 v96, s4, v96
    v_xor_b32 v97, s4, v97
    v_xor_b32 v98, s4, v98
    v_xor_b32 v99, s4, v99
    v_xor_b32 v100, s4, v100
    v_xor_b32 v101, s4, v101
    v_xor_b32 v102, s4, v102
    v_xor_b32 v103, s4, v103
    v_xor_b32 v104, s4, v104
    v_xor_b32 v105, s4, v105
    v_xor_b32 v106, s4, v106
    v_xor_b32 v107, s4, v107
    v_xor_b32 v108, s4, v108
    v_xor_b32 v109, s4, v109
    v_xor_b32 v110, s4, v110
    v_xor_b32 v111, s4, v111
    v_or3_b32 v33, v96, v97, v98
    v_or3_b32 v33, v33, v99, v100
    v_or3_b32 v33, v33, v101, v102
    v_or3_b32 v33, v33, v103, v104
    v_or3_b32 v33, v33, v105, v106
    v_or3_b32 v33, v33, v107, v108
    v_or3_b32 v33, v33, v109, v110
    v_or_b32 v33, v33, v111
    v_and_b32 v33, 0x80008000, v33
    v_cmp_ne_u32 vcc, 0, v33
    s_nop 4
    s_cbranch_vccz L_hb0
    s_add_u32 s87, s87, 1
    s_cmp_lt_u32 s87, 4096
    s_cbranch_scc1 L_hr0_again
    s_branch L_hb0
L_hr1:
    s_mov_b32 s87, 0
L_hr1_again:
    s_add_u32 s79, s101, 1
    s_cmp_ge_u32 s79, 10
    s_cselect_b32 s91, 10, 0
    s_sub_u32 s79, s79, s91
    s_lshl_b32 s79, s79, 12
    s_add_u32 s79, s79, s85
    buffer_load_dwordx4 v[112:115], v2, s[52:55], s79 offen offset:0 sc1
    buffer_load_dwordx4 v[116:119], v2, s[52:55], s79 offen offset:1024 sc1
    buffer_load_dwordx4 v[120:123], v2, s[52:55], s79 offen offset:2048 sc1
    buffer_load_dwordx4 v[124:127], v2, s[52:55], s79 offen offset:3072 sc1
    s_waitcnt vmcnt(0)
    v_xor_b32 v112, s4, v112
    v_xor_b32 v113, s4, v113
    v_xor_b32 v114, s4, v114
    v_xor_b32 v115, s4, v115
    v_xor_b32 v116, s4, v116
    v_xor_b32 v117, s4, v117
    v_xor_b32 v118, s4, v118
    v_xor_b32 v119, s4, v119
    v_xor_b32 v120, s4, v120
    v_xor_b32 v121, s4, v121
    v_xor_b32 v122, s4, v122
    v_xor_b32 v123, s4, v123
    v_xor_b32 v124, s4, v124
    v_xor_b32 v125, s4, v125
    v_xor_b32 v126, s4, v126
    v_xor_b32 v127, s4, v127
    v_or3_b32 v33, v112, v113, v114
    v_or3_b32 v33, v33, v115, v116
    v_or3_b32 v33, v33, v117, v118
    v_or3_b32 v33, v33, v119, v120
    v_or3_b32 v33, v33, v121, v122
    v_or3_b32 v33, v33, v123, v124
    v_or3_b32 v33, v33, v125, v126
    v_or_b32 v33, v33, v127
    v_and_b32 v33, 0x80008000, v33
    v_cmp_ne_u32 vcc, 0, v33
    s_nop 4
    s_cbranch_vccz L_hb1
    s_add_u32 s87, s87, 1
    s_cmp_lt_u32 s87, 4096
    s_cbranch_scc1 L_hr1_again
    s_branch L_hb1
L_hr2:
    s_mov_b32 s87, 0
L_hr2_again:
    s_add_u32 s79, s101, 2
    s_cmp_ge_u32 s79, 10
    s_cselect_b32 s91, 10, 0
    s_sub_u32 s79, s79, s91
    s_lshl_b32 s79, s79, 12
    s_add_u32 s79, s79, s85
    buffer_load_dwordx4 v[128:131], v2, s[52:55], s79 offen offset:0 sc1
    buffer_load_dwordx4 v[132:135], v2, s[52:55], s79 offen offset:1024 sc1
    buffer_load_dwordx4 v[136:139], v2, s[52:55], s79 offen offset:2048 sc1
    buffer_load_dwordx4 v[140:143], v2, s[52:55], s79 offen offset:3072 sc1
    s_waitcnt vmcnt(0)
    v_xor_b32 v128, s4, v128
    v_xor_b32 v129, s4, v129
    v_xor_b32 v130, s4, v130
    v_xor_b32 v131, s4, v131
    v_xor_b32 v132, s4, v132
    v_xor_b32 v133, s4, v133
    v_xor_b32 v134, s4, v134
    v_xor_b32 v135, s4, v135
    v_xor_b32 v136, s4, v136
    v_xor_b32 v137, s4, v137
    v_xor_b32 v138, s4, v138
    v_xor_b32 v139, s4, v139
    v_xor_b32 v140, s4, v140
    v_xor_b32 v141, s4, v141
    v_xor_b32 v142, s4, v142
    v_xor_b32 v143, s4, v143
    v_or3_b32 v33, v128, v129, v130
    v_or3_b32 v33, v33, v131, v132
    v_or3_b32 v33, v33, v133, v134
    v_or3_b32 v33, v33, v135, v136
    v_or3_b32 v33, v33, v137, v138
    v_or3_b32 v33, v33, v139, v140
    v_or3_b32 v33, v33, v141, v142
    v_or_b32 v33, v33, v143
    v_and_b32 v33, 0x80008000, v33
    v_cmp_ne_u32 vcc, 0, v33
    s_nop 4
    s_cbranch_vccz L_hb2
    s_add_u32 s87, s87, 1
    s_cmp_lt_u32 s87, 4096
    s_cbranch_scc1 L_hr2_again
    s_branch L_hb2
L_hr3:
    s_mov_b32 s87, 0
L_hr3_again:
    s_add_u32 s79, s101, 3
    s_cmp_ge_u32 s79, 10
    s_cselect_b32 s91, 10, 0
    s_sub_u32 s79, s79, s91
    s_lshl_b32 s79, s79, 12
    s_add_u32 s79, s79, s85
    buffer_load_dwordx4 v[144:147], v2, s[52:55], s79 offen offset:0 sc1
    buffer_load_dwordx4 v[148:151], v2, s[52:55], s79 offen offset:1024 sc1
    buffer_load_dwordx4 v[152:155], v2, s[52:55], s79 offen offset:2048 sc1
    buffer_load_dwordx4 v[156:159], v2, s[52:55], s79 offen offset:3072 sc1
    s_waitcnt vmcnt(0)
    v_xor_b32 v144, s4, v144
    v_xor_b32 v145, s4, v145
    v_xor_b32 v146, s4, v146
    v_xor_b32 v147, s4, v147
    v_xor_b32 v148, s4, v148
    v_xor_b32 v149, s4, v149
    v_xor_b32 v150, s4, v150
    v_xor_b32 v151, s4, v151
    v_xor_b32 v152, s4, v152
    v_xor_b32 v153, s4, v153
    v_xor_b32 v154, s4, v154
    v_xor_b32 v155, s4, v155
    v_xor_b32 v156, s4, v156
    v_xor_b32 v157, s4, v157
    v_xor_b32 v158, s4, v158
    v_xor_b32 v159, s4, v159
    v_or3_b32 v33, v144, v145, v146
    v_or3_b32 v33, v33, v147, v148
    v_or3_b32 v33, v33, v149, v150
    v_or3_b32 v33, v33, v151, v152
    v_or3_b32 v33, v33, v153, v154
    v_or3_b32 v33, v33, v155, v156
    v_or3_b32 v33, v33, v157, v158
    v_or_b32 v33, v33, v159
    v_and_b32 v33, 0x80008000, v33
    v_cmp_ne_u32 vcc, 0, v33
    s_nop 4
    s_cbranch_vccz L_hb3
    s_add_u32 s87, s87, 1
    s_cmp_lt_u32 s87, 4096
    s_cbranch_scc1 L_hr3_again
    s_branch L_hb3
L_hr4:
    s_mov_b32 s87, 0
L_hr4_again:
    s_add_u32 s79, s101, 4
    s_cmp_ge_u32 s79, 10
    s_cselect_b32 s91, 10, 0
    s_sub_u32 s79, s79, s91
    s_lshl_b32 s79, s79, 12
    s_add_u32 s79, s79, s85
    buffer_load_dwordx4 v[96:99], v2, s[52:55], s79 offen offset:0 sc1
    buffer_load_dwordx4 v[100:103], v2, s[52:55], s79 offen offset:1024 sc1
    buffer_load_dwordx4 v[104:107], v2, s[52:55], s79 offen offset:2048 sc1
    buffer_load_dwordx4 v[108:111], v2, s[52:55], s79 offen offset:3072 sc1
    s_waitcnt vmcnt(0)
    v_xor_b32 v96, s4, v96
    v_xor_b32 v97, s4, v97
    v_xor_b32 v98, s4, v98
    v_xor_b32 v99, s4, v99
    v_xor_b32 v100, s4, v100
    v_xor_b32 v101, s4, v101
    v_xor_b32 v102, s4, v102
    v_xor_b32 v103, s4, v103
    v_xor_b32 v104, s4, v104
    v_xor_b32 v105, s4, v105
    v_xor_b32 v106, s4, v106
    v_xor_b32 v107, s4, v107
    v_xor_b32 v108, s4, v108
    v_xor_b32 v109, s4, v109
    v_xor_b32 v110, s4, v110
    v_xor_b32 v111, s4, v111
    v_or3_b32 v33, v96, v97, v98
    v_or3_b32 v33, v33, v99, v100
    v_or3_b32 v33, v33, v101, v102
    v_or3_b32 v33, v33, v103, v104
    v_or3_b32 v33, v33, v105, v106
    v_or3_b32 v33, v33, v107, v108
    v_or3_b32 v33, v33, v109, v110
    v_or_b32 v33, v33, v111
    v_and_b32 v33, 0x80008000, v33
    v_cmp_ne_u32 vcc, 0, v33
    s_nop 4
    s_cbranch_vccz L_hb4
    s_add_u32 s87, s87, 1
    s_cmp_lt_u32 s87, 4096
    s_cbranch_scc1 L_hr4_again
    s_branch L_hb4
L_hr5:
    s_mov_b32 s87, 0
L_hr5_again:
    s_add_u32 s79, s101, 5
    s_cmp_ge_u32 s79, 10
    s_cselect_b32 s91, 10, 0
    s_sub_u32 s79, s79, s91
    s_lshl_b32 s79, s79, 12
    s_add_u32 s79, s79, s85
    buffer_load_dwordx4 v[112:115], v2, s[52:55], s79 offen offset:0 sc1
    buffer_load_dwordx4 v[116:119], v2, s[52:55], s79 offen offset:1024 sc1
    buffer_load_dwordx4 v[120:123], v2, s[52:55], s79 offen offset:2048 sc1
    buffer_load_dwordx4 v[124:127], v2, s[52:55], s79 offen offset:3072 sc1
    s_waitcnt vmcnt(0)
    v_xor_b32 v112, s4, v112
    v_xor_b32 v113, s4, v113
    v_xor_b32 v114, s4, v114
    v_xor_b32 v115, s4, v115
    v_xor_b32 v116, s4, v116
    v_xor_b32 v117, s4, v117
    v_xor_b32 v118, s4, v118
    v_xor_b32 v119, s4, v119
    v_xor_b32 v120, s4, v120
    v_xor_b32 v121, s4, v121
    v_xor_b32 v122, s4, v122
    v_xor_b32 v123, s4, v123
    v_xor_b32 v124, s4, v124
    v_xor_b32 v125, s4, v125
    v_xor_b32 v126, s4, v126
    v_xor_b32 v127, s4, v127
    v_or3_b32 v33, v112, v113, v114
    v_or3_b32 v33, v33, v115, v116
    v_or3_b32 v33, v33, v117, v118
    v_or3_b32 v33, v33, v119, v120
    v_or3_b32 v33, v33, v121, v122
    v_or3_b32 v33, v33, v123, v124
    v_or3_b32 v33, v33, v125, v126
    v_or_b32 v33, v33, v127
    v_and_b32 v33, 0x80008000, v33
    v_cmp_ne_u32 vcc, 0, v33
    s_nop 4
    s_cbranch_vccz L_hb5
    s_add_u32 s87, s87, 1
    s_cmp_lt_u32 s87, 4096
    s_cbranch_scc1 L_hr5_again
    s_branch L_hb5
L_hr6:
    s_mov_b32 s87, 0
L_hr6_again:
    s_add_u32 s79, s101, 6
    s_cmp_ge_u32 s79, 10
    s_cselect_b32 s91, 10, 0
    s_sub_u32 s79, s79, s91
    s_lshl_b32 s79, s79, 12
    s_add_u32 s79, s79, s85
    buffer_load_dwordx4 v[128:131], v2, s[52:55], s79 offen offset:0 sc1
    buffer_load_dwordx4 v[132:135], v2, s[52:55], s79 offen offset:1024 sc1
    buffer_load_dwordx4 v[136:139], v2, s[52:55], s79 offen offset:2048 sc1
    buffer_load_dwordx4 v[140:143], v2, s[52:55], s79 offen offset:3072 sc1
    s_waitcnt vmcnt(0)
    v_xor_b32 v128, s4, v128
    v_xor_b32 v129, s4, v129
    v_xor_b32 v130, s4, v130
    v_xor_b32 v131, s4, v131
    v_xor_b32 v132, s4, v132
    v_xor_b32 v133, s4, v133
    v_xor_b32 v134, s4, v134
    v_xor_b32 v135, s4, v135
    v_xor_b32 v136, s4, v136
    v_xor_b32 v137, s4, v137
    v_xor_b32 v138, s4, v138
    v_xor_b32 v139, s4, v139
    v_xor_b32 v140, s4, v140
    v_xor_b32 v141, s4, v141
    v_xor_b32 v142, s4, v142
    v_xor_b32 v143, s4, v143
    v_or3_b32 v33, v128, v129, v130
    v_or3_b32 v33, v33, v131, v132
    v_or3_b32 v33, v33, v133, v134
    v_or3_b32 v33, v33, v135, v136
    v_or3_b32 v33, v33, v137, v138
    v_or3_b32 v33, v33, v139, v140
    v_or3_b32 v33, v33, v141, v142
    v_or_b32 v33, v33, v143
    v_and_b32 v33, 0x80008000, v33
    v_cmp_ne_u32 vcc, 0, v33
    s_nop 4
    s_cbranch_vccz L_hb6
    s_add_u32 s87, s87, 1
    s_cmp_lt_u32 s87, 4096
    s_cbranch_scc1 L_hr6_again
    s_branch L_hb6
L_hr7:
    s_mov_b32 s87, 0
L_hr7_again:
    s_add_u32 s79, s101, 7
    s_cmp_ge_u32 s79, 10
    s_cselect_b32 s91, 10, 0
    s_sub_u32 s79, s79, s91
    s_lshl_b32 s79, s79, 12
    s_add_u32 s79, s79, s85
    buffer_load_dwordx4 v[144:147], v2, s[52:55], s79 offen offset:0 sc1
    buffer_load_dwordx4 v[148:151], v2, s[52:55], s79 offen offset:1024 sc1
    buffer_load_dwordx4 v[152:155], v2, s[52:55], s79 offen offset:2048 sc1
    buffer_load_dwordx4 v[156:159], v2, s[52:55], s79 offen offset:3072 sc1
    s_waitcnt vmcnt(0)
    v_xor_b32 v144, s4, v144
    v_xor_b32 v145, s4, v145
    v_xor_b32 v146, s4, v146
    v_xor_b32 v147, s4, v147
    v_xor_b32 v148, s4, v148
    v_xor_b32 v149, s4, v149
    v_xor_b32 v150, s4, v150
    v_xor_b32 v151, s4, v151
    v_xor_b32 v152, s4, v152
    v_xor_b32 v153, s4, v153
    v_xor_b32 v154, s4, v154
    v_xor_b32 v155, s4, v155
    v_xor_b32 v156, s4, v156
    v_xor_b32 v157, s4, v157
    v_xor_b32 v158, s4, v158
    v_xor_b32 v159, s4, v159
    v_or3_b32 v33, v144, v145, v146
    v_or3_b32 v33, v33, v147, v148
    v_or3_b32 v33, v33, v149, v150
    v_or3_b32 v33, v33, v151, v152
    v_or3_b32 v33, v33, v153, v154
    v_or3_b32 v33, v33, v155, v156
    v_or3_b32 v33, v33, v157, v158
    v_or_b32 v33, v33, v159
    v_and_b32 v33, 0x80008000, v33
    v_cmp_ne_u32 vcc, 0, v33
    s_nop 4
    s_cbranch_vccz L_hb7
    s_add_u32 s87, s87, 1
    s_cmp_lt_u32 s87, 4096
    s_cbranch_scc1 L_hr7_again
    s_branch L_hb7
L_hr8:
    s_mov_b32 s87, 0
L_hr8_again:
    s_add_u32 s79, s101, 8
    s_cmp_ge_u32 s79, 10
    s_cselect_b32 s91, 10, 0
    s_sub_u32 s79, s79, s91
    s_lshl_b32 s79, s79, 12
    s_add_u32 s79, s79, s85
    buffer_load_dwordx4 v[96:99], v2, s[52:55], s79 offen offset:0 sc1
    buffer_load_dwordx4 v[100:103], v2, s[52:55], s79 offen offset:1024 sc1
    buffer_load_dwordx4 v[104:107], v2, s[52:55], s79 offen offset:2048 sc1
    buffer_load_dwordx4 v[108:111], v2, s[52:55], s79 offen offset:3072 sc1
    s_waitcnt vmcnt(0)
    v_xor_b32 v96, s4, v96
    v_xor_b32 v97, s4, v97
    v_xor_b32 v98, s4, v98
    v_xor_b32 v99, s4, v99
    v_xor_b32 v100, s4, v100
    v_xor_b32 v101, s4, v101
    v_xor_b32 v102, s4, v102
    v_xor_b32 v103, s4, v103
    v_xor_b32 v104, s4, v104
    v_xor_b32 v105, s4, v105
    v_xor_b32 v106, s4, v106
    v_xor_b32 v107, s4, v107
    v_xor_b32 v108, s4, v108
    v_xor_b32 v109, s4, v109
    v_xor_b32 v110, s4, v110
    v_xor_b32 v111, s4, v111
    v_or3_b32 v33, v96, v97, v98
    v_or3_b32 v33, v33, v99, v100
    v_or3_b32 v33, v33, v101, v102
    v_or3_b32 v33, v33, v103, v104
    v_or3_b32 v33, v33, v105, v106
    v_or3_b32 v33, v33, v107, v108
    v_or3_b32 v33, v33, v109, v110
    v_or_b32 v33, v33, v111
    v_and_b32 v33, 0x80008000, v33
    v_cmp_ne_u32 vcc, 0, v33
    s_nop 4
    s_cbranch_vccz L_hb8
    s_add_u32 s87, s87, 1
    s_cmp_lt_u32 s87, 4096
    s_cbranch_scc1 L_hr8_again
    s_branch L_hb8
L_hr9:
    s_mov_b32 s87, 0
L_hr9_again:
    s_add_u32 s79, s101, 9
    s_cmp_ge_u32 s79, 10
    s_cselect_b32 s91, 10, 0
    s_sub_u32 s79, s79, s91
    s_lshl_b32 s79, s79, 12
    s_add_u32 s79, s79, s85
    buffer_load_dwordx4 v[112:115], v2, s[52:55], s79 offen offset:0 sc1
    buffer_load_dwordx4 v[116:119], v2, s[52:55], s79 offen offset:1024 sc1
    buffer_load_dwordx4 v[120:123], v2, s[52:55], s79 offen offset:2048 sc1
    buffer_load_dwordx4 v[124:127], v2, s[52:55], s79 offen offset:3072 sc1
    s_waitcnt vmcnt(0)
    v_xor_b32 v112, s4, v112
    v_xor_b32 v113, s4, v113
    v_xor_b32 v114, s4, v114
    v_xor_b32 v115, s4, v115
    v_xor_b32 v116, s4, v116
    v_xor_b32 v117, s4, v117
    v_xor_b32 v118, s4, v118
    v_xor_b32 v119, s4, v119
    v_xor_b32 v120, s4, v120
    v_xor_b32 v121, s4, v121
    v_xor_b32 v122, s4, v122
    v_xor_b32 v123, s4, v123
    v_xor_b32 v124, s4, v124
    v_xor_b32 v125, s4, v125
    v_xor_b32 v126, s4, v126
    v_xor_b32 v127, s4, v127
    v_or3_b32 v33, v112, v113, v114
    v_or3_b32 v33, v33, v115, v116
    v_or3_b32 v33, v33, v117, v118
    v_or3_b32 v33, v33, v119, v120
    v_or3_b32 v33, v33, v121, v122
    v_or3_b32 v33, v33, v123, v124
    v_or3_b32 v33, v33, v125, v126
    v_or_b32 v33, v33, v127
    v_and_b32 v33, 0x80008000, v33
    v_cmp_ne_u32 vcc, 0, v33
    s_nop 4
    s_cbranch_vccz L_hb9
    s_add_u32 s87, s87, 1
    s_cmp_lt_u32 s87, 4096
    s_cbranch_scc1 L_hr9_again
    s_branch L_hb9
L_hr10:
    s_mov_b32 s87, 0
L_hr10_again:
    s_mov_b32 s79, 10
    s_lshl_b32 s79, s79, 12
    s_add_u32 s79, s79, s85
    buffer_load_dwordx4 v[128:131], v2, s[52:55], s79 offen offset:0 sc1
    buffer_load_dwordx4 v[132:135], v2, s[52:55], s79 offen offset:1024 sc1
    buffer_load_dwordx4 v[136:139], v2, s[52:55], s79 offen offset:2048 sc1
    s_waitcnt vmcnt(0)
    v_xor_b32 v128, s4, v128
    v_xor_b32 v129, s4, v129
    v_xor_b32 v130, s4, v130
    v_xor_b32 v131, s4, v131
    v_xor_b32 v132, s4, v132
    v_xor_b32 v133, s4, v133
    v_xor_b32 v134, s4, v134
    v_xor_b32 v135, s4, v135
    v_xor_b32 v136, s4, v136
    v_xor_b32 v137, s4, v137
    v_xor_b32 v138, s4, v138
    v_xor_b32 v139, s4, v139
    v_or3_b32 v33, v128, v129, v130
    v_or3_b32 v33, v33, v131, v132
    v_or3_b32 v33, v33, v133, v134
    v_or3_b32 v33, v33, v135, v136
    v_or3_b32 v33, v33, v137, v138
    v_or_b32 v33, v33, v139
    v_and_b32 v33, 0x80008000, v33
    v_cmp_ne_u32 vcc, 0, v33
    s_nop 4
    s_cbranch_vccz L_hb10
    s_add_u32 s87, s87, 1
    s_cmp_lt_u32 s87, 4096
    s_cbranch_scc1 L_hr10_again
    s_branch L_hb10
L_idleC:
    s_lshr_b32 s74, s60, 1
    v_and_b32 v4, 15, v0
    v_lshrrev_b32 v5, 4, v0
    s_mul_i32 s75, s74, 4672
    s_add_u32 s75, s75, 152080
    v_lshlrev_b32 v6, 5, v4
    v_lshl_add_u32 v6, v5, 4, v6
    v_add_u32 v8, s75, v6
    v_sub_u32 v6, 3, v4
    v_and_b32 v6, 3, v6
    s_mul_i32 s75, s74, 10496
    s_add_u32 s75, s75, 114688
    v_mul_u32_u24 v7, 2624, v6
    v_add_u32 v7, s75, v7
    v_add_u32 v6, v6, v4
    v_lshlrev_b32 v12, 3, v5
    v_sub_u32 v12, v12, v6
    v_add_u32 v12, 27, v12
    v_lshl_add_u32 v9, v12, 1, v7
    v_lshlrev_b32 v12, 2, v5
    v_sub_u32 v12, v12, v6
    v_add_u32 v12, 19, v12
    v_lshl_add_u32 v10, v12, 1, v7
    s_lshl_b32 s75, s74, 2
    s_add_u32 s75, s75, 161408
    v_mov_b32 v11, s75
    v_add_u32 v6, 4, v4
    v_mov_b32 v7, 511
    v_lshlrev_b32 v7, v6, v7
    v_lshlrev_b32 v6, 3, v5
    v_lshrrev_b32 v7, v6, v7
    v_bfe_u32 v6, v7, 0, 1
    v_bfe_u32 v12, v7, 1, 1
    v_lshl_or_b32 v6, v12, 16, v6
    v_mul_u32_u24 v56, 0x3c00, v6
    v_bfe_u32 v6, v7, 2, 1
    v_bfe_u32 v12, v7, 3, 1
    v_lshl_or_b32 v6, v12, 16, v6
    v_mul_u32_u24 v57, 0x3c00, v6
    v_bfe_u32 v6, v7, 4, 1
    v_bfe_u32 v12, v7, 5, 1
    v_lshl_or_b32 v6, v12, 16, v6
    v_mul_u32_u24 v58, 0x3c00, v6
    v_bfe_u32 v6, v7, 6, 1
    v_bfe_u32 v12, v7, 7, 1
    v_lshl_or_b32 v6, v12, 16, v6
    v_mul_u32_u24 v59, 0x3c00, v6
    v_add_u32 v6, 5, v4
    v_mov_b32 v7, 127
    v_lshlrev_b32 v7, v6, v7
    v_lshlrev_b32 v6, 3, v5
    v_lshrrev_b32 v7, v6, v7
    v_bfe_u32 v6, v7, 0, 1
    v_bfe_u32 v12, v7, 1, 1
    v_lshl_or_b32 v6, v12, 16, v6
    v_mul_u32_u24 v60, 0x3c00, v6
    v_bfe_u32 v6, v7, 2, 1
    v_bfe_u32 v12, v7, 3, 1
    v_lshl_or_b32 v6, v12, 16, v6
    v_mul_u32_u24 v61, 0x3c00, v6
    v_bfe_u32 v6, v7, 4, 1
    v_bfe_u32 v12, v7, 5, 1
    v_lshl_or_b32 v6, v12, 16, v6
    v_mul_u32_u24 v62, 0x3c00, v6
    v_bfe_u32 v6, v7, 6, 1
    v_bfe_u32 v12, v7, 7, 1
    v_lshl_or_b32 v6, v12, 16, v6
    v_mul_u32_u24 v63, 0x3c00, v6
    s_barrier
    s_barrier
    s_barrier
    s_barrier
    s_barrier
    s_barrier
    s_barrier
    s_barrier
    s_barrier
    s_waitcnt vmcnt(0)
    v_readfirstlane_b32 s63, v3
    s_nop 0
    s_not_b32 s63, s63
    s_bfe_u32 s74, s63, 0x1000f
    s_and_b32 s63, s63, 0x7fffffff
    s_lshl_b32 s74, s74, 31
    s_or_b32 s63, s63, s74
    s_and_b32 s65, s63, 0xffff
    s_and_b32 s64, s63, 0xffff0000
    s_and_b32 s11, s63, 0x10001
    s_and_b32 s4, s63, 0x80008000
    s_branch L_epi_done
L_roleH:
    s_lshr_b32 s74, s62, 2
    s_and_b32 s75, s62, 3
    s_lshl_b32 s75, s75, 1
    s_add_u32 s74, s74, s75
    s_and_b32 s100, s74, 7
    s_cmp_ge_u32 s74, 10
    s_cselect_b32 s75, 10, 0
    s_sub_u32 s101, s74, s75
    s_cmp_ge_u32 s74, 7
    s_cselect_b32 s75, 7, 0
    s_sub_u32 s100, s74, s75
    s_mov_b32 s90, 152064
    v_lshrrev_b32 v33, 3, v0
    v_lshlrev_b32 v33, 10, v33
    v_and_b32 v34, 7, v0
    v_lshrrev_b32 v35, 4, v0
    v_xor_b32 v36, v34, v35
    v_lshl_add_u32 v240, v36, 4, v33
    v_xor_b32 v36, 4, v36
    v_lshl_add_u32 v241, v36, 4, v33
    v_add_u32 v241, 7168, v241
    v_add_u32 v242, 14336, v240
    v_add_u32 v243, 14336, v241
    s_mov_b32 s74, 0x15555556
    s_movk_i32 s75, 2752
    v_add_u32 v33, 0, v0
    v_mul_hi_u32 v34, v33, s74
    v_mul_u32_u24 v35, 12, v34
    v_sub_u32 v35, v33, v35
    v_lshlrev_b32 v35, 4, v35
    v_mad_u32_u24 v244, v34, s75, v35
    v_add_u32 v33, 64, v0
    v_mul_hi_u32 v34, v33, s74
    v_mul_u32_u24 v35, 12, v34
    v_sub_u32 v35, v33, v35
    v_lshlrev_b32 v35, 4, v35
    v_mad_u32_u24 v245, v34, s75, v35
    v_subrev_u32 v245, 1024, v245
    v_add_u32 v33, 128, v0
    v_mul_hi_u32 v34, v33, s74
    v_mul_u32_u24 v35, 12, v34
    v_sub_u32 v35, v33, v35
    v_lshlrev_b32 v35, 4, v35
    v_mad_u32_u24 v246, v34, s75, v35
    v_subrev_u32 v246, 2048, v246
    s_lshl_b32 s74, s68, 10
    s_lshl_b32 s75, s69, 1
    s_cmp_eq_u32 s70, 1
    s_cselect_b32 s74, s74, 2147418112
    s_cselect_b32 s75, s75, 2147418112
    s_lshl_b32 s76, s92, 15
    s_add_u32 s82, s74, s76
    s_mul_i32 s76, s92, 44032
    s_add_u32 s83, s75, s76
    s_lshl_b32 s98, s92, 12
    s_mul_i32 s99, s92, 3072
    s_add_u32 s99, s99, 16384
    s_add_u32 s84, s100, 0
    s_cmp_ge_u32 s84, 7
    s_cselect_b32 s74, 7, 0
    s_sub_u32 s84, s84, s74
    s_cmp_ge_u32 s84, 3
    s_addc_u32 s84, s84, 0
    s_lshl_b32 s74, s84, 7
    s_add_u32 m0, s98, 0
    s_add_u32 s74, s74, s82
    buffer_load_dwordx4 v240, s[40:43], s74 offen offset:0 lds
    buffer_load_dwordx4 v241, s[40:43], s74 offen offset:1024 lds
    buffer_load_dwordx4 v242, s[40:43], s74 offen offset:2048 lds
    buffer_load_dwordx4 v243, s[40:43], s74 offen offset:3072 lds
    s_mul_i32 s75, s84, 176128
    s_add_u32 m0, s99, 0
    s_add_u32 s75, s75, s83
    buffer_load_dwordx4 v244, s[44:47], s75 offen offset:0 lds
    buffer_load_dwordx4 v245, s[44:47], s75 offen offset:1024 lds
    buffer_load_dwordx4 v246, s[44:47], s75 offen offset:2048 lds
    s_mul_i32 s74, s93, 10496
    s_add_u32 s74, s74, 114688
    v_mov_b32 v34, 0
    v_mov_b32 v35, 0
    v_mov_b32 v36, 0
    v_mov_b32 v37, 0
    v_add_u32 v33, s74, v2
    s_lshl_b32 s75, s94, 10
    v_add_u32 v33, s75, v33
    ds_write_b128 v33, v[34:37]
    v_cmp_gt_u32 vcc, 36, v0
    s_cmp_eq_u32 s94, 0
    s_cselect_b64 s[88:89], -1, 0
    s_and_b64 exec, vcc, s[88:89]
    ds_write_b128 v33, v[34:37] offset:2048
    s_mov_b64 exec, -1
    s_waitcnt vmcnt(11)
    v_lshlrev_b32 v40, 16, v4
    v_lshlrev_b32 v48, 16, v8
    v_and_b32 v41, 0xffff0000, v4
    v_and_b32 v49, 0xffff0000, v8
    v_lshlrev_b32 v42, 16, v5
    v_lshlrev_b32 v50, 16, v9
    v_and_b32 v43, 0xffff0000, v5
    v_and_b32 v51, 0xffff0000, v9
    v_lshlrev_b32 v44, 16, v6
    v_lshlrev_b32 v52, 16, v10
    v_and_b32 v45, 0xffff0000, v6
    v_and_b32 v53, 0xffff0000, v10
    v_lshlrev_b32 v46, 16, v7
    v_lshlrev_b32 v54, 16, v11
    v_and_b32 v47, 0xffff0000, v7
    v_and_b32 v55, 0xffff0000, v11
    v_add_f32 v56, v40, v41
    v_add_f32 v64, v48, v49
    v_add_f32 v57, v42, v43
    v_add_f32 v65, v50, v51
    v_add_f32 v58, v44, v45
    v_add_f32 v66, v52, v53
    v_add_f32 v59, v46, v47
    v_add_f32 v67, v54, v55
    v_add_f32 v56, v56, v57
    v_add_f32 v64, v64, v65
    v_add_f32 v58, v58, v59
    v_add_f32 v66, v66, v67
    v_add_f32 v56, v56, v58
    v_add_f32 v64, v64, v66
    s_nop 0
    v_add_f32_dpp v56, v56, v56 row_shr:1 row_mask:0xf bank_mask:0xf
    v_add_f32_dpp v64, v64, v64 row_shr:1 row_mask:0xf bank_mask:0xf
    s_nop 0
    v_add_f32_dpp v56, v56, v56 row_shr:2 row_mask:0xf bank_mask:0xf
    v_add_f32_dpp v64, v64, v64 row_shr:2 row_mask:0xf bank_mask:0xf
    s_nop 0
    v_add_f32_dpp v56, v56, v56 row_shr:4 row_mask:0xf bank_mask:0xf
    v_add_f32_dpp v64, v64, v64 row_shr:4 row_mask:0xf bank_mask:0xf
    s_nop 0
    v_add_f32_dpp v56, v56, v56 row_shr:8 row_mask:0xf bank_mask:0xf
    v_add_f32_dpp v64, v64, v64 row_shr:8 row_mask:0xf bank_mask:0xf
    s_nop 0
    v_add_f32_dpp v56, v56, v56 row_bcast:15 row_mask:0xa bank_mask:0xf
    v_add_f32_dpp v64, v64, v64 row_bcast:15 row_mask:0xa bank_mask:0xf
    s_nop 0
    v_add_f32_dpp v56, v56, v56 row_bcast:31 row_mask:0xc bank_mask:0xf
    v_add_f32_dpp v64, v64, v64 row_bcast:31 row_mask:0xc bank_mask:0xf
    v_readlane_b32 s74, v56, 63
    v_readlane_b32 s75, v64, 63
    v_mov_b32 v57, 0x3b000000
    v_mov_b32 v65, 0x3b000000
    v_mul_f32 v57, s74, v57
    v_mul_f32 v65, s75, v65
    v_sub_f32 v58, v40, v57
    v_sub_f32 v66, v48, v65
    v_mul_f32 v56, v58, v58
    v_mul_f32 v64, v66, v66
    v_sub_f32 v59, v41, v57
    v_sub_f32 v67, v49, v65
    v_fmac_f32 v56, v59, v59
    v_fmac_f32 v64, v67, v67
    v_sub_f32 v58, v42, v57
    v_sub_f32 v66, v50, v65
    v_fmac_f32 v56, v58, v58
    v_fmac_f32 v64, v66, v66
    v_sub_f32 v59, v43, v57
    v_sub_f32 v67, v51, v65
    v_fmac_f32 v56, v59, v59
    v_fmac_f32 v64, v67, v67
    v_sub_f32 v58, v44, v57
    v_sub_f32 v66, v52, v65
    v_fmac_f32 v56, v58, v58
    v_fmac_f32 v64, v66, v66
    v_sub_f32 v59, v45, v57
    v_sub_f32 v67, v53, v65
    v_fmac_f32 v56, v59, v59
    v_fmac_f32 v64, v67, v67
    v_sub_f32 v58, v46, v57
    v_sub_f32 v66, v54, v65
    v_fmac_f32 v56, v58, v58
    v_fmac_f32 v64, v66, v66
    v_sub_f32 v59, v47, v57
    v_sub_f32 v67, v55, v65
    v_fmac_f32 v56, v59, v59
    v_fmac_f32 v64, v67, v67
    s_nop 0
    v_add_f32_dpp v56, v56, v56 row_shr:1 row_mask:0xf bank_mask:0xf
    v_add_f32_dpp v64, v64, v64 row_shr:1 row_mask:0xf bank_mask:0xf
    s_nop 0
    v_add_f32_dpp v56, v56, v56 row_shr:2 row_mask:0xf bank_mask:0xf
    v_add_f32_dpp v64, v64, v64 row_shr:2 row_mask:0xf bank_mask:0xf
    s_nop 0
    v_add_f32_dpp v56, v56, v56 row_shr:4 row_mask:0xf bank_mask:0xf
    v_add_f32_dpp v64, v64, v64 row_shr:4 row_mask:0xf bank_mask:0xf
    s_nop 0
    v_add_f32_dpp v56, v56, v56 row_shr:8 row_mask:0xf bank_mask:0xf
    v_add_f32_dpp v64, v64, v64 row_shr:8 row_mask:0xf bank_mask:0xf
    s_nop 0
    v_add_f32_dpp v56, v56, v56 row_bcast:15 row_mask:0xa bank_mask:0xf
    v_add_f32_dpp v64, v64, v64 row_bcast:15 row_mask:0xa bank_mask:0xf
    s_nop 0
    v_add_f32_dpp v56, v56, v56 row_bcast:31 row_mask:0xc bank_mask:0xf
    v_add_f32_dpp v64, v64, v64 row_bcast:31 row_mask:0xc bank_mask:0xf
    v_readlane_b32 s74, v56, 63
    v_readlane_b32 s75, v64, 63
    v_cvt_pk_bf16_f32 v60, v57, v57
    v_cvt_pk_bf16_f32 v68, v65, v65
    v_and_b32 v60, 0xffff0000, v60
    v_and_b32 v68, 0xffff0000, v68
    v_mov_b32 v58, 0x3b000000
    v_mov_b32 v66, 0x3b000000
    v_mul_f32 v58, s74, v58
    v_mul_f32 v66, s75, v66
    v_cvt_pk_bf16_f32 v58, v58, v58
    v_cvt_pk_bf16_f32 v66, v66, v66
    v_and_b32 v58, 0xffff0000, v58
    v_and_b32 v66, 0xffff0000, v66
    v_add_f32 v58, 0x3727c5ac, v58
    v_add_f32 v66, 0x3727c5ac, v66
    v_cvt_pk_bf16_f32 v58, v58, v58
    v_cvt_pk_bf16_f32 v66, v66, v66
    v_and_b32 v58, 0xffff0000, v58
    v_and_b32 v66, 0xffff0000, v66
    v_sqrt_f32 v59, v58
    v_sqrt_f32 v67, v66
    v_rcp_f32 v61, v59
    v_rcp_f32 v69, v67
    v_fma_f32 v63, -v59, v59, v58
    v_fma_f32 v71, -v67, v67, v66
    v_mul_f32 v61, 0.5, v61
    v_mul_f32 v69, 0.5, v69
    v_fmac_f32 v59, v63, v61
    v_fmac_f32 v67, v71, v69
    v_cvt_pk_bf16_f32 v59, v59, v59
    v_cvt_pk_bf16_f32 v67, v67, v67
    v_and_b32 v59, 0xffff0000, v59
    v_and_b32 v67, 0xffff0000, v67
    v_rcp_f32 v62, v59
    v_rcp_f32 v70, v67
    v_fma_f32 v63, -v59, v62, 1.0
    v_fma_f32 v71, -v67, v70, 1.0
    v_fmac_f32 v62, v63, v62
    v_fmac_f32 v70, v71, v70
    v_mul_f32 v63, v60, v62
    v_mul_f32 v71, v68, v70
    v_fma_f32 v40, v40, v62, -v63
    v_fma_f32 v48, v48, v70, -v71
    v_fma_f32 v41, v41, v62, -v63
    v_fma_f32 v49, v49, v70, -v71
    v_fma_f32 v42, v42, v62, -v63
    v_fma_f32 v50, v50, v70, -v71
    v_fma_f32 v43, v43, v62, -v63
    v_fma_f32 v51, v51, v70, -v71
    v_fma_f32 v44, v44, v62, -v63
    v_fma_f32 v52, v52, v70, -v71
    v_fma_f32 v45, v45, v62, -v63
    v_fma_f32 v53, v53, v70, -v71
    v_fma_f32 v46, v46, v62, -v63
    v_fma_f32 v54, v54, v70, -v71
    v_fma_f32 v47, v47, v62, -v63
    v_fma_f32 v55, v55, v70, -v71
    v_cvt_pk_f16_f32 v4, v40, v41
    v_cvt_pk_f16_f32 v8, v48, v49
    v_cvt_pk_f16_f32 v5, v42, v43
    v_cvt_pk_f16_f32 v9, v50, v51
    v_cvt_pk_f16_f32 v6, v44, v45
    v_cvt_pk_f16_f32 v10, v52, v53
    v_cvt_pk_f16_f32 v7, v46, v47
    v_cvt_pk_f16_f32 v11, v54, v55
    s_mul_i32 s74, s92, 2080
    s_add_u32 s74, s74, 152064
    v_add_u32 v16, s74, v2
    ds_write_b128 v16, v[4:7]
    ds_write_b128 v16, v[8:11] offset:1040
    v_mov_b32 v230, v60
    v_mov_b32 v231, v62
    v_mov_b32 v232, v68
    v_mov_b32 v233, v70
    s_add_u32 s84, s100, 1
    s_cmp_ge_u32 s84, 7
    s_cselect_b32 s74, 7, 0
    s_sub_u32 s84, s84, s74
    s_cmp_ge_u32 s84, 3
    s_addc_u32 s84, s84, 0
    s_lshl_b32 s74, s84, 7
    s_add_u32 m0, s98, 28672
    s_add_u32 s74, s74, s82
    buffer_load_dwordx4 v240, s[40:43], s74 offen offset:0 lds
    buffer_load_dwordx4 v241, s[40:43], s74 offen offset:1024 lds
    buffer_load_dwordx4 v242, s[40:43], s74 offen offset:2048 lds
    buffer_load_dwordx4 v243, s[40:43], s74 offen offset:3072 lds
    s_mul_i32 s75, s84, 176128
    s_add_u32 m0, s99, 28672
    s_add_u32 s75, s75, s83
    buffer_load_dwordx4 v244, s[44:47], s75 offen offset:0 lds
    buffer_load_dwordx4 v245, s[44:47], s75 offen offset:1024 lds
    buffer_load_dwordx4 v246, s[44:47], s75 offen offset:2048 lds
    s_cmp_eq_u32 s70, 0
    s_cbranch_scc0 L_pf0
    v_lshrrev_b32 v172, 3, v0
    v_lshlrev_b32 v172, 10, v172
    v_and_b32 v173, 7, v0
    v_lshl_add_u32 v172, v173, 4, v172
    s_and_b32 s76, s62, 1
    s_xor_b32 s74, s61, 1
    s_lshl_b32 s74, s74, 8
    s_lshl_b32 s75, s76, 7
    s_add_u32 s74, s74, s75
    s_lshl_b32 s75, s92, 5
    s_add_u32 s74, s74, s75
    s_lshl_b32 s74, s74, 10
    s_add_u32 s74, s74, 384
    buffer_load_dwordx4 v[168:171], v172, s[40:43], s74 offen
    s_add_u32 s74, s74, 8192
    buffer_load_dwordx4 v[168:171], v172, s[40:43], s74 offen
    s_add_u32 s74, s74, 8192
    buffer_load_dwordx4 v[168:171], v172, s[40:43], s74 offen
    s_add_u32 s74, s74, 8192
    buffer_load_dwordx4 v[168:171], v172, s[40:43], s74 offen
    s_add_u32 s74, s74, 8192
    s_mul_i32 s74, s76, 688
    s_mul_i32 s75, s92, 172
    s_add_u32 s74, s74, s75
    s_lshl_b32 s74, s74, 10
    s_add_u32 s74, s74, 384
    buffer_load_dwordx4 v[168:171], v172, s[48:51], s74 offen
    s_add_u32 s74, s74, 8192
    buffer_load_dwordx4 v[168:171], v172, s[48:51], s74 offen
    s_add_u32 s74, s74, 8192
    buffer_load_dwordx4 v[168:171], v172, s[48:51], s74 offen
    s_add_u32 s74, s74, 8192
    buffer_load_dwordx4 v[168:171], v172, s[48:51], s74 offen
    s_add_u32 s74, s74, 8192
    buffer_load_dwordx4 v[168:171], v172, s[48:51], s74 offen
    s_add_u32 s74, s74, 8192
L_pf0:
    s_waitcnt lgkmcnt(0)
    s_barrier
    s_waitcnt vmcnt(17)
    v_readfirstlane_b32 s63, v3
    s_nop 0
    s_not_b32 s63, s63
    s_bfe_u32 s74, s63, 0x1000f
    s_and_b32 s63, s63, 0x7fffffff
    s_lshl_b32 s74, s74, 31
    s_or_b32 s63, s63, s74
    s_and_b32 s65, s63, 0xffff
    s_and_b32 s64, s63, 0xffff0000
    s_and_b32 s11, s63, 0x10001
    v_cmp_eq_u32 vcc, 0, v0
    v_mov_b32 v225, s63
    v_mov_b32 v227, s63
    v_cndmask_b32 v224, v232, v230, vcc
    v_cndmask_b32 v226, v233, v231, vcc
    s_lshl_b32 s74, s92, 1
    s_add_u32 s74, s74, s66
    s_lshl_b32 s74, s74, 4
    s_add_u32 s74, s74, 4096
    s_mov_b64 exec, 3
    buffer_store_dwordx4 v[224:227], v2, s[52:55], s74 offen sc1
    s_mov_b64 exec, -1
    v_subrev_u32 v190, 256, v1
    v_bfe_u32 v228, v0, 2, 2
    v_mul_u32_u24 v228, 1040, v228
    v_lshrrev_b32 v229, 4, v0
    v_lshl_add_u32 v228, v229, 5, v228
    v_and_b32 v229, 3, v0
    v_lshl_add_u32 v228, v229, 3, v228
    s_lshl_b32 s74, s92, 8
    s_add_u32 s74, s74, 152064
    v_add_u32 v228, s74, v228
    ds_read_b64_tr_b16 v[208:209], v228 offset:0
    ds_read_b64_tr_b16 v[210:211], v228 offset:4160
    ds_read_b64_tr_b16 v[212:213], v228 offset:128
    ds_read_b64_tr_b16 v[214:215], v228 offset:4288
    v_mov_b32 v229, 0x10001
    s_mul_i32 s74, s67, 8320
    s_lshl_b32 s75, s92, 11
    s_add_u32 s74, s74, s75
    s_add_u32 s74, s74, 65536
    s_waitcnt lgkmcnt(2)
    v_bfi_b32 v208, v229, s11, v208
    v_bfi_b32 v209, v229, s11, v209
    v_bfi_b32 v210, v229, s11, v210
    v_bfi_b32 v211, v229, s11, v211
    buffer_store_dwordx4 v[208:211], v2, s[52:55], s74 offen offset:0 sc1
    s_waitcnt lgkmcnt(0)
    v_bfi_b32 v212, v229, s11, v212
    v_bfi_b32 v213, v229, s11, v213
    v_bfi_b32 v214, v229, s11, v214
    v_bfi_b32 v215, v229, s11, v215
    buffer_store_dwordx4 v[212:215], v2, s[52:55], s74 offen offset:1024 sc1
    s_add_u32 s84, s100, 2
    s_cmp_ge_u32 s84, 7
    s_cselect_b32 s74, 7, 0
    s_sub_u32 s84, s84, s74
    s_cmp_ge_u32 s84, 3
    s_addc_u32 s84, s84, 0
    s_lshl_b32 s74, s84, 7
    s_add_u32 m0, s98, 57344
    s_add_u32 s74, s74, s82
    buffer_load_dwordx4 v240, s[40:43], s74 offen offset:0 lds
    buffer_load_dwordx4 v241, s[40:43], s74 offen offset:1024 lds
    buffer_load_dwordx4 v242, s[40:43], s74 offen offset:2048 lds
    buffer_load_dwordx4 v243, s[40:43], s74 offen offset:3072 lds
    s_mul_i32 s75, s84, 176128
    s_add_u32 m0, s99, 57344
    s_add_u32 s75, s75, s83
    buffer_load_dwordx4 v244, s[44:47], s75 offen offset:0 lds
    buffer_load_dwordx4 v245, s[44:47], s75 offen offset:1024 lds
    buffer_load_dwordx4 v246, s[44:47], s75 offen offset:2048 lds
    s_cmp_eq_u32 s70, 0
    s_cbranch_scc0 L_pf1
    v_lshrrev_b32 v172, 3, v0
    v_lshlrev_b32 v172, 10, v172
    v_and_b32 v173, 7, v0
    v_lshl_add_u32 v172, v173, 4, v172
    s_and_b32 s76, s62, 1
    s_mul_i32 s74, s76, 688
    s_mul_i32 s75, s92, 172
    s_add_u32 s74, s74, s75
    s_lshl_b32 s74, s74, 10
    s_add_u32 s74, s74, 41344
    buffer_load_dwordx4 v[168:171], v172, s[48:51], s74 offen
    s_add_u32 s74, s74, 8192
    buffer_load_dwordx4 v[168:171], v172, s[48:51], s74 offen
    s_add_u32 s74, s74, 8192
    buffer_load_dwordx4 v[168:171], v172, s[48:51], s74 offen
    s_add_u32 s74, s74, 8192
    buffer_load_dwordx4 v[168:171], v172, s[48:51], s74 offen
    s_add_u32 s74, s74, 8192
    buffer_load_dwordx4 v[168:171], v172, s[48:51], s74 offen
    s_add_u32 s74, s74, 8192
    buffer_load_dwordx4 v[168:171], v172, s[48:51], s74 offen
    s_add_u32 s74, s74, 8192
    buffer_load_dwordx4 v[168:171], v172, s[48:51], s74 offen
    s_add_u32 s74, s74, 8192
    buffer_load_dwordx4 v[168:171], v172, s[48:51], s74 offen
    s_add_u32 s74, s74, 8192
    buffer_load_dwordx4 v[168:171], v172, s[48:51], s74 offen
    s_add_u32 s74, s74, 8192
L_pf1:
    s_cmp_eq_u32 s70, 0
    s_cbranch_scc1 L_nwp
    s_waitcnt vmcnt(17)
L_nwp:
    s_waitcnt lgkmcnt(0)
    s_barrier
    s_add_u32 s84, s100, 3
    s_cmp_ge_u32 s84, 7
    s_cselect_b32 s74, 7, 0
    s_sub_u32 s84, s84, s74
    s_cmp_ge_u32 s84, 3
    s_addc_u32 s84, s84, 0
    s_lshl_b32 s74, s84, 7
    s_add_u32 m0, s98, 86016
    s_add_u32 s74, s74, s82
    buffer_load_dwordx4 v240, s[40:43], s74 offen offset:0 lds
    buffer_load_dwordx4 v241, s[40:43], s74 offen offset:1024 lds
    buffer_load_dwordx4 v242, s[40:43], s74 offen offset:2048 lds
    buffer_load_dwordx4 v243, s[40:43], s74 offen offset:3072 lds
    s_mul_i32 s75, s84, 176128
    s_add_u32 m0, s99, 86016
    s_add_u32 s75, s75, s83
    buffer_load_dwordx4 v244, s[44:47], s75 offen offset:0 lds
    buffer_load_dwordx4 v245, s[44:47], s75 offen offset:1024 lds
    buffer_load_dwordx4 v246, s[44:47], s75 offen offset:2048 lds
    v_lshlrev_b32 v167, 16, v167
    s_lshl_b32 s74, s93, 13
    s_add_u32 s74, s74, 135680
    v_add_u32 v33, s74, v2
    v_mov_b32 v35, s74
    ds_read_b128 v[128:131], v33 offset:0
    ds_read_b128 v[172:175], v33 offset:4096
    ds_read_b128 v[132:135], v33 offset:1024
    ds_read_b128 v[176:179], v33 offset:5120
    ds_read_b128 v[136:139], v33 offset:2048
    ds_read_b128 v[180:183], v33 offset:6144
    ds_read_b32 v39, v35 offset:3072
    ds_read_b32 v38, v35 offset:7168
    s_mul_i32 s74, s93, 4672
    s_add_u32 s74, s74, 152064
    v_mov_b32 v34, 0
    v_mov_b32 v35, 0
    v_mov_b32 v36, 0
    v_mov_b32 v37, 0
    v_add_u32 v33, s74, v2
    v_cmp_gt_u32 vcc, 34, v0
    s_nop 0
    s_mov_b64 exec, vcc
    ds_write_b128 v33, v[34:37]
    v_cmp_gt_u32 vcc, 2, v0
    s_nop 0
    s_mov_b64 exec, vcc
    ds_write_b128 v33, v[34:37] offset:4640
    s_mov_b64 exec, -1
    v_lshlrev_b32 v34, 16, v188
    v_and_b32 v35, 0xffff0000, v188
    v_lshlrev_b32 v33, 3, v0
    v_add_u32 v33, 161856, v33
    v_cmp_gt_u32 vcc, 48, v0
    s_nop 0
    s_mov_b64 exec, vcc
    ds_write_b64 v33, v[34:35]
    s_mov_b64 exec, -1
    s_cmp_eq_u32 s70, 0
    s_cbranch_scc1 L_nw0
    s_waitcnt vmcnt(17)
L_nw0:
    s_barrier
    s_waitcnt lgkmcnt(0)
    v_and_b32 v34, 0x7fffffff, v167
    v_mul_f32 v34, 0x3a800000, v34
    v_max3_f32 v34, v34, v38, v39
    v_rcp_f32 v35, v34
    s_nop 0
    v_mul_f32 v38, v38, v35
    v_mul_f32 v39, v39, v35
    v_mul_f32 v36, v167, v35
    s_lshl_b32 s74, s93, 2
    s_add_u32 s74, s74, 161408
    v_mov_b32 v37, s74
    ds_write_b32 v37, v34
    v_mul_f32 v46, 0x43000000, v34
    v_mov_b32 v47, s63
    s_add_u32 s75, s71, s93
    s_lshl_b32 s75, s75, 3
    s_add_u32 s75, s75, 49152
    s_mov_b64 exec, 1
    buffer_store_dwordx2 v[46:47], off, s[52:55], s75 sc1
    s_mov_b64 exec, -1
    v_mul_f32 v128, v39, v128
    v_fmac_f32 v128, v38, v172
    v_mul_f32 v129, v39, v129
    v_fmac_f32 v129, v38, v173
    v_mul_f32 v130, v39, v130
    v_fmac_f32 v130, v38, v174
    v_mul_f32 v131, v39, v131
    v_fmac_f32 v131, v38, v175
    v_mul_f32 v132, v39, v132
    v_fmac_f32 v132, v38, v176
    v_mul_f32 v133, v39, v133
    v_fmac_f32 v133, v38, v177
    v_mul_f32 v134, v39, v134
    v_fmac_f32 v134, v38, v178
    v_mul_f32 v135, v39, v135
    v_fmac_f32 v135, v38, v179
    v_mul_f32 v136, v39, v136
    v_fmac_f32 v136, v38, v180
    v_mul_f32 v137, v39, v137
    v_fmac_f32 v137, v38, v181
    v_mul_f32 v138, v39, v138
    v_fmac_f32 v138, v38, v182
    v_mul_f32 v139, v39, v139
    v_fmac_f32 v139, v38, v183
    v_cmp_eq_u32 vcc, 0, v0
    s_nop 1
    v_cndmask_b32 v36, 0, v36, vcc
    v_add_f32 v128, v128, v36
    s_mul_i32 s74, s93, 10496
    s_add_u32 s74, s74, 114688
    v_and_b32 v33, 15, v0
    v_lshrrev_b32 v34, 4, v0
    v_cvt_pk_f16_f32 v40, v132, v133
    v_cvt_pk_f16_f32 v41, v134, v135
    v_cvt_pk_f16_f32 v42, v136, v137
    v_cvt_pk_f16_f32 v43, v138, v139
    v_cvt_pk_f16_f32 v44, v131, v130
    v_cvt_pk_f16_f32 v45, v129, v128
    s_cmp_eq_u32 s70, 0
    s_cbranch_scc1 L_nw1
    s_waitcnt vmcnt(8)
L_nw1:
    s_barrier
    s_add_u32 s84, s100, 4
    s_cmp_ge_u32 s84, 7
    s_cselect_b32 s74, 7, 0
    s_sub_u32 s84, s84, s74
    s_cmp_ge_u32 s84, 3
    s_addc_u32 s84, s84, 0
    s_lshl_b32 s74, s84, 7
    s_add_u32 m0, s98, 0
    s_add_u32 s74, s74, s82
    buffer_load_dwordx4 v240, s[40:43], s74 offen offset:0 lds
    buffer_load_dwordx4 v241, s[40:43], s74 offen offset:1024 lds
    buffer_load_dwordx4 v242, s[40:43], s74 offen offset:2048 lds
    buffer_load_dwordx4 v243, s[40:43], s74 offen offset:3072 lds
    s_mul_i32 s75, s84, 176128
    s_add_u32 m0, s99, 0
    s_add_u32 s75, s75, s83
    buffer_load_dwordx4 v244, s[44:47], s75 offen offset:0 lds
    buffer_load_dwordx4 v245, s[44:47], s75 offen offset:1024 lds
    buffer_load_dwordx4 v246, s[44:47], s75 offen offset:2048 lds
    s_cmp_eq_u32 s70, 0
    s_cbranch_scc1 L_nw2
    s_waitcnt vmcnt(8)
L_nw2:
    s_waitcnt lgkmcnt(0)
    s_barrier
    s_add_u32 s84, s100, 5
    s_cmp_ge_u32 s84, 7
    s_cselect_b32 s74, 7, 0
    s_sub_u32 s84, s84, s74
    s_cmp_ge_u32 s84, 3
    s_addc_u32 s84, s84, 0
    s_lshl_b32 s74, s84, 7
    s_add_u32 m0, s98, 28672
    s_add_u32 s74, s74, s82
    buffer_load_dwordx4 v240, s[40:43], s74 offen offset:0 lds
    buffer_load_dwordx4 v241, s[40:43], s74 offen offset:1024 lds
    buffer_load_dwordx4 v242, s[40:43], s74 offen offset:2048 lds
    buffer_load_dwordx4 v243, s[40:43], s74 offen offset:3072 lds
    s_mul_i32 s75, s84, 176128
    s_add_u32 m0, s99, 28672
    s_add_u32 s75, s75, s83
    buffer_load_dwordx4 v244, s[44:47], s75 offen offset:0 lds
    buffer_load_dwordx4 v245, s[44:47], s75 offen offset:1024 lds
    buffer_load_dwordx4 v246, s[44:47], s75 offen offset:2048 lds
    s_cmp_eq_u32 s70, 0
    s_cbranch_scc1 L_nw3
    s_waitcnt vmcnt(7)
L_nw3:
    s_barrier
    s_add_u32 s84, s100, 6
    s_cmp_ge_u32 s84, 7
    s_cselect_b32 s74, 7, 0
    s_sub_u32 s84, s84, s74
    s_cmp_ge_u32 s84, 3
    s_addc_u32 s84, s84, 0
    s_lshl_b32 s74, s84, 7
    s_add_u32 m0, s98, 57344
    s_add_u32 s74, s74, s82
    buffer_load_dwordx4 v240, s[40:43], s74 offen offset:0 lds
    buffer_load_dwordx4 v241, s[40:43], s74 offen offset:1024 lds
    buffer_load_dwordx4 v242, s[40:43], s74 offen offset:2048 lds
    buffer_load_dwordx4 v243, s[40:43], s74 offen offset:3072 lds
    s_mul_i32 s75, s84, 176128
    s_add_u32 m0, s99, 57344
    s_add_u32 s75, s75, s83
    buffer_load_dwordx4 v244, s[44:47], s75 offen offset:0 lds
    buffer_load_dwordx4 v245, s[44:47], s75 offen offset:1024 lds
    buffer_load_dwordx4 v246, s[44:47], s75 offen offset:2048 lds
    s_cmp_eq_u32 s70, 0
    s_cbranch_scc1 L_nw4
    s_waitcnt vmcnt(7)
L_nw4:
    s_barrier
    s_mov_b32 s84, 3
    s_lshl_b32 s74, s84, 7
    s_add_u32 m0, s98, 86016
    s_add_u32 s74, s74, s82
    buffer_load_dwordx4 v240, s[40:43], s74 offen offset:0 lds
    buffer_load_dwordx4 v241, s[40:43], s74 offen offset:1024 lds
    buffer_load_dwordx4 v242, s[40:43], s74 offen offset:2048 lds
    buffer_load_dwordx4 v243, s[40:43], s74 offen offset:3072 lds
    s_mul_i32 s75, s84, 176128
    s_add_u32 m0, s99, 86016
    s_add_u32 s75, s75, s83
    buffer_load_dwordx4 v244, s[44:47], s75 offen offset:0 lds
    buffer_load_dwordx4 v245, s[44:47], s75 offen offset:1024 lds
    buffer_load_dwordx4 v246, s[44:47], s75 offen offset:2048 lds
    v_and_b32 v33, 15, v0
    v_lshrrev_b32 v34, 4, v0
    s_mul_i32 s74, s93, 10496
    s_add_u32 s74, s74, 114688
    s_cmp_eq_u32 s94, 0
    s_cbranch_scc0 L_kc2
    v_lshlrev_b32 v35, 8, v34
    v_lshl_add_u32 v35, v33, 3, v35
    v_sub_u32 v35, 926, v35
    v_lshlrev_b32 v35, 1, v35
    v_add_u32 v35, s74, v35
    v_cmp_le_u32 vcc, 32, v0
    s_nop 0
    s_mov_b64 exec, vcc
    v_readlane_b32 s75, v41, 31
    s_mov_b32 s76, 0x03020302
    s_mov_b32 s77, 0x01000302
    s_mov_b32 s78, 0x01000100
    s_lshr_b32 s75, s75, 16
    s_lshl_b32 s75, s75, 16
    v_perm_b32 v46, v40, v40, s76
    v_perm_b32 v47, v40, v40, s77
    v_perm_b32 v48, v40, v40, s78
    ds_write2_b32 v35, v46, v47 offset0:64 offset1:65
    v_and_b32 v49, 0xffff, v48
    v_or_b32 v49, s75, v49
    v_cmp_eq_u32 vcc, 32, v0
    s_nop 1
    v_cndmask_b32 v49, v48, v49, vcc
    ds_write2_b32 v35, v48, v49 offset0:66 offset1:67
    v_perm_b32 v46, v41, v41, s76
    v_perm_b32 v47, v41, v41, s77
    v_perm_b32 v48, v41, v41, s78
    ds_write2_b32 v35, v46, v47 offset0:0 offset1:1
    ds_write2_b32 v35, v48, v48 offset0:2 offset1:3
    s_mov_b64 exec, -1
    s_mov_b32 exec_hi, 0
    v_lshrrev_b32 v36, 1, v33
    v_lshl_add_u32 v36, v34, 5, v36
    v_and_b32 v37, 1, v33
    v_mul_u32_u24 v38, 206, v37
    v_sub_u32 v36, 44, v36
    v_lshlrev_b32 v36, 1, v36
    v_add3_u32 v36, v36, v38, s74
    ds_write_b16 v36, v42 offset:2224
    ds_write_b16_d16_hi v36, v42 offset:2208
    ds_write_b16 v36, v43 offset:2192
    ds_write_b16_d16_hi v36, v43 offset:2176
    s_mov_b64 exec, -1
    v_readlane_b32 s75, v42, 0
    v_readlane_b32 s76, v42, 32
    v_lshlrev_b32 v35, 1, v0
    v_add_u32 v35, s74, v35
    v_mov_b32 v36, s75
    v_mov_b32 v37, 0
    v_mov_b32 v38, s76
    s_mov_b64 exec, 0x7f
    ds_write_b16 v35, v36 offset:62
    s_mov_b64 exec, 1
    ds_write_b16 v35, v37 offset:2312
    ds_write_b16 v35, v38 offset:2184
    s_mov_b64 exec, -1
    s_branch L_kc
L_kc2:
    v_lshlrev_b32 v35, 7, v34
    v_lshl_add_u32 v35, v33, 3, v35
    v_sub_u32 v35, 797, v35
    v_lshlrev_b32 v35, 1, v35
    v_add_u32 v35, s74, v35
    s_mov_b32 exec_hi, 0
    ds_write_b16_d16_hi v35, v41 offset:0
    ds_write_b16 v35, v41 offset:2
    ds_write_b16 v35, v41 offset:4
    ds_write_b16 v35, v41 offset:6
    ds_write_b16_d16_hi v35, v40 offset:8
    ds_write_b16 v35, v40 offset:10
    ds_write_b16 v35, v40 offset:12
    ds_write_b16 v35, v40 offset:14
    s_mov_b64 exec, -1
    v_lshrrev_b32 v35, 1, v34
    v_lshlrev_b32 v35, 7, v35
    v_lshl_add_u32 v35, v33, 3, v35
    v_and_b32 v36, 1, v34
    v_lshl_add_u32 v35, v36, 2, v35
    v_sub_u32 v35, 1056, v35
    v_lshlrev_b32 v35, 1, v35
    v_add_u32 v35, s74, v35
    ds_write_b64 v35, v[44:45]
L_kc:
    s_cmp_eq_u32 s70, 0
    s_cbranch_scc1 L_nw5
    s_waitcnt vmcnt(7)
L_nw5:
    s_barrier
    v_subrev_u32 v190, 256, v1
    v_lshrrev_b32 v33, 1, v190
    v_mul_u32_u24 v33, 8320, v33
    v_and_b32 v34, 1, v190
    v_lshl_add_u32 v191, v34, 4, v33
    s_lshl_b32 s74, s71, 4
    s_add_u32 s82, s74, 65536
    s_add_u32 s74, s82, 0
    buffer_load_dwordx4 v[192:195], v191, s[52:55], s74 offen sc1
    s_add_u32 s74, s82, 1064960
    buffer_load_dwordx4 v[196:199], v191, s[52:55], s74 offen sc1
    s_mov_b32 s83, 152608
    v_lshrrev_b32 v33, 3, v0
    v_lshlrev_b32 v33, 10, v33
    v_and_b32 v34, 7, v0
    v_bfe_u32 v35, v0, 4, 1
    v_lshlrev_b32 v35, 2, v35
    v_xor_b32 v34, v34, v35
    v_lshl_add_u32 v189, v34, 4, v33
    s_lshr_b32 s74, s92, 1
    s_and_b32 s75, s92, 1
    s_mul_i32 s76, s74, 704512
    s_lshl_b32 s77, s75, 15
    s_add_u32 s76, s76, s77
    s_lshl_b32 s77, s73, 1
    s_add_u32 s85, s76, s77
    s_lshl_b32 s74, s74, 13
    s_lshl_b32 s75, s75, 12
    s_add_u32 s86, s74, s75
    s_add_u32 s74, s101, 0
    s_cmp_ge_u32 s74, 10
    s_cselect_b32 s91, 10, 0
    s_sub_u32 s74, s74, s91
    s_lshl_b32 s74, s74, 16
    s_add_u32 s74, s74, s85
    s_add_u32 m0, s86, 0
    s_add_u32 s75, s74, 0
    buffer_load_dwordx4 v189, s[48:51], s75 offen lds
    s_add_u32 m0, s86, 1024
    s_add_u32 s75, s74, 8192
    buffer_load_dwordx4 v189, s[48:51], s75 offen lds
    s_add_u32 m0, s86, 2048
    s_add_u32 s75, s74, 16384
    buffer_load_dwordx4 v189, s[48:51], s75 offen lds
    s_add_u32 m0, s86, 3072
    s_add_u32 s75, s74, 24576
    buffer_load_dwordx4 v189, s[48:51], s75 offen lds
    s_cmp_eq_u32 s70, 0
    s_cbranch_scc1 L_nw6
    s_waitcnt vmcnt(6)
L_nw6:
    s_barrier
    s_add_u32 s74, s101, 1
    s_cmp_ge_u32 s74, 10
    s_cselect_b32 s91, 10, 0
    s_sub_u32 s74, s74, s91
    s_lshl_b32 s74, s74, 16
    s_add_u32 s74, s74, s85
    s_add_u32 m0, s86, 16384
    s_add_u32 s75, s74, 0
    buffer_load_dwordx4 v189, s[48:51], s75 offen lds
    s_add_u32 m0, s86, 17408
    s_add_u32 s75, s74, 8192
    buffer_load_dwordx4 v189, s[48:51], s75 offen lds
    s_add_u32 m0, s86, 18432
    s_add_u32 s75, s74, 16384
    buffer_load_dwordx4 v189, s[48:51], s75 offen lds
    s_add_u32 m0, s86, 19456
    s_add_u32 s75, s74, 24576
    buffer_load_dwordx4 v189, s[48:51], s75 offen lds
    s_waitcnt lgkmcnt(0)
    s_barrier
    s_barrier
    v_lshrrev_b32 v33, 1, v190
    v_lshlrev_b32 v33, 4, v33
    v_and_b32 v34, 1, v190
    v_mul_u32_u24 v34, 4672, v34
    v_add3_u32 v33, v33, v34, s83
    s_waitcnt vmcnt(8)
    s_mov_b32 s87, 0
L_u_chk:
    v_bitop3_b32 v34, s11, v192, v193 bitop3:0x7e
    v_bitop3_b32 v35, s11, v194, v195 bitop3:0x7e
    v_or_b32 v36, v34, v35
    v_bitop3_b32 v34, s11, v196, v197 bitop3:0x7e
    v_bitop3_b32 v35, s11, v198, v199 bitop3:0x7e
    v_or3_b32 v36, v36, v34, v35
    v_and_b32 v36, 0x10001, v36
    v_cmp_ne_u32 vcc, 0, v36
    s_nop 4
    s_cbranch_vccz L_u_ok
    s_add_u32 s87, s87, 1
    s_cmp_ge_u32 s87, 4096
    s_cbranch_scc1 L_u_ok
    s_add_u32 s74, s82, 0
    buffer_load_dwordx4 v[192:195], v191, s[52:55], s74 offen sc1
    s_add_u32 s74, s82, 1064960
    buffer_load_dwordx4 v[196:199], v191, s[52:55], s74 offen sc1
    s_waitcnt vmcnt(0)
    s_branch L_u_chk
L_u_ok:
    v_and_b32 v192, 0xfffefffe, v192
    v_and_b32 v193, 0xfffefffe, v193
    v_and_b32 v194, 0xfffefffe, v194
    v_and_b32 v195, 0xfffefffe, v195
    ds_write_b128 v33, v[192:195] offset:0
    v_and_b32 v196, 0xfffefffe, v196
    v_and_b32 v197, 0xfffefffe, v197
    v_and_b32 v198, 0xfffefffe, v198
    v_and_b32 v199, 0xfffefffe, v199
    ds_write_b128 v33, v[196:199] offset:2048
    s_waitcnt lgkmcnt(0)
    s_mul_i32 s74, s93, 10496
    s_add_u32 s74, s74, 114688
    s_lshl_b32 s75, s94, 10
    s_add_u32 s74, s74, s75
    v_add_u32 v33, s74, v2
    v_add_u32 v56, 5248, v33
    ds_read_b128 v[40:43], v33 offset:0
    ds_read_b64 v[44:45], v33 offset:16
    s_waitcnt lgkmcnt(0)
    v_alignbit_b32 v48, v41, v40, 16
    v_alignbit_b32 v49, v42, v41, 16
    v_alignbit_b32 v50, v43, v42, 16
    v_alignbit_b32 v51, v44, v43, 16
    v_alignbit_b32 v52, v42, v41, 16
    v_alignbit_b32 v53, v43, v42, 16
    v_alignbit_b32 v54, v44, v43, 16
    v_alignbit_b32 v55, v45, v44, 16
    ds_write_b128 v33, v[48:51] offset:2624
    ds_write2_b32 v56, v41, v42 offset0:0 offset1:1
    ds_write2_b32 v56, v43, v44 offset0:2 offset1:3
    ds_write_b128 v33, v[52:55] offset:7872
    v_cmp_gt_u32 vcc, 34, v0
    s_cmp_eq_u32 s94, 0
    s_cselect_b64 s[88:89], -1, 0
    s_and_b64 exec, vcc, s[88:89]
    s_cbranch_execz L_kb
    v_add_u32 v56, 2048, v56
    ds_read_b128 v[40:43], v33 offset:2048
    ds_read_b64 v[44:45], v33 offset:2064
    s_waitcnt lgkmcnt(0)
    v_alignbit_b32 v48, v41, v40, 16
    v_alignbit_b32 v49, v42, v41, 16
    v_alignbit_b32 v50, v43, v42, 16
    v_alignbit_b32 v51, v44, v43, 16
    v_alignbit_b32 v52, v42, v41, 16
    v_alignbit_b32 v53, v43, v42, 16
    v_alignbit_b32 v54, v44, v43, 16
    v_alignbit_b32 v55, v45, v44, 16
    ds_write_b128 v33, v[48:51] offset:4672
    ds_write2_b32 v56, v41, v42 offset0:0 offset1:1
    ds_write2_b32 v56, v43, v44 offset0:2 offset1:3
    ds_write_b128 v33, v[52:55] offset:9920
L_kb:
    s_mov_b64 exec, -1
    s_waitcnt lgkmcnt(0)
    s_waitcnt lgkmcnt(0)
    s_waitcnt lgkmcnt(0)
    s_barrier
    s_add_u32 s74, s101, 2
    s_cmp_ge_u32 s74, 10
    s_cselect_b32 s91, 10, 0
    s_sub_u32 s74, s74, s91
    s_lshl_b32 s74, s74, 16
    s_add_u32 s74, s74, s85
    s_add_u32 m0, s86, 32768
    s_add_u32 s75, s74, 0
    buffer_load_dwordx4 v189, s[48:51], s75 offen lds
    s_add_u32 m0, s86, 33792
    s_add_u32 s75, s74, 8192
    buffer_load_dwordx4 v189, s[48:51], s75 offen lds
    s_add_u32 m0, s86, 34816
    s_add_u32 s75, s74, 16384
    buffer_load_dwordx4 v189, s[48:51], s75 offen lds
    s_add_u32 m0, s86, 35840
    s_add_u32 s75, s74, 24576
    buffer_load_dwordx4 v189, s[48:51], s75 offen lds
    s_add_u32 s74, s101, 3
    s_cmp_ge_u32 s74, 10
    s_cselect_b32 s91, 10, 0
    s_sub_u32 s74, s74, s91
    s_lshl_b32 s74, s74, 16
    s_add_u32 s74, s74, s85
    s_add_u32 m0, s86, 49152
    s_add_u32 s75, s74, 0
    buffer_load_dwordx4 v189, s[48:51], s75 offen lds
    s_add_u32 m0, s86, 50176
    s_add_u32 s75, s74, 8192
    buffer_load_dwordx4 v189, s[48:51], s75 offen lds
    s_add_u32 m0, s86, 51200
    s_add_u32 s75, s74, 16384
    buffer_load_dwordx4 v189, s[48:51], s75 offen lds
    s_add_u32 m0, s86, 52224
    s_add_u32 s75, s74, 24576
    buffer_load_dwordx4 v189, s[48:51], s75 offen lds
    s_waitcnt vmcnt(4)
    s_add_u32 s74, s101, 4
    s_cmp_ge_u32 s74, 10
    s_cselect_b32 s91, 10, 0
    s_sub_u32 s74, s74, s91
    s_lshl_b32 s74, s74, 16
    s_add_u32 s74, s74, s85
    s_add_u32 m0, s86, 65536
    s_add_u32 s75, s74, 0
    buffer_load_dwordx4 v189, s[48:51], s75 offen lds
    s_add_u32 m0, s86, 66560
    s_add_u32 s75, s74, 8192
    buffer_load_dwordx4 v189, s[48:51], s75 offen lds
    s_add_u32 m0, s86, 67584
    s_add_u32 s75, s74, 16384
    buffer_load_dwordx4 v189, s[48:51], s75 offen lds
    s_add_u32 m0, s86, 68608
    s_add_u32 s75, s74, 24576
    buffer_load_dwordx4 v189, s[48:51], s75 offen lds
    s_waitcnt vmcnt(4)
    s_add_u32 s74, s101, 5
    s_cmp_ge_u32 s74, 10
    s_cselect_b32 s91, 10, 0
    s_sub_u32 s74, s74, s91
    s_lshl_b32 s74, s74, 16
    s_add_u32 s74, s74, s85
    s_add_u32 m0, s86, 81920
    s_add_u32 s75, s74, 0
    buffer_load_dwordx4 v189, s[48:51], s75 offen lds
    s_add_u32 m0, s86, 82944
    s_add_u32 s75, s74, 8192
    buffer_load_dwordx4 v189, s[48:51], s75 offen lds
    s_add_u32 m0, s86, 83968
    s_add_u32 s75, s74, 16384
    buffer_load_dwordx4 v189, s[48:51], s75 offen lds
    s_add_u32 m0, s86, 84992
    s_add_u32 s75, s74, 24576
    buffer_load_dwordx4 v189, s[48:51], s75 offen lds
    s_waitcnt vmcnt(4)
    s_add_u32 s74, s101, 6
    s_cmp_ge_u32 s74, 10
    s_cselect_b32 s91, 10, 0
    s_sub_u32 s74, s74, s91
    s_lshl_b32 s74, s74, 16
    s_add_u32 s74, s74, s85
    s_add_u32 m0, s86, 98304
    s_add_u32 s75, s74, 0
    buffer_load_dwordx4 v189, s[48:51], s75 offen lds
    s_add_u32 m0, s86, 99328
    s_add_u32 s75, s74, 8192
    buffer_load_dwordx4 v189, s[48:51], s75 offen lds
    s_add_u32 m0, s86, 100352
    s_add_u32 s75, s74, 16384
    buffer_load_dwordx4 v189, s[48:51], s75 offen lds
    s_add_u32 m0, s86, 101376
    s_add_u32 s75, s74, 24576
    buffer_load_dwordx4 v189, s[48:51], s75 offen lds
    s_waitcnt vmcnt(4)
    s_add_u32 s74, s101, 7
    s_cmp_ge_u32 s74, 10
    s_cselect_b32 s91, 10, 0
    s_sub_u32 s74, s74, s91
    s_lshl_b32 s74, s74, 16
    s_add_u32 s74, s74, s85
    s_add_u32 m0, s86, 135680
    s_add_u32 s75, s74, 0
    buffer_load_dwordx4 v189, s[48:51], s75 offen lds
    s_add_u32 m0, s86, 136704
    s_add_u32 s75, s74, 8192
    buffer_load_dwordx4 v189, s[48:51], s75 offen lds
    s_add_u32 m0, s86, 137728
    s_add_u32 s75, s74, 16384
    buffer_load_dwordx4 v189, s[48:51], s75 offen lds
    s_add_u32 m0, s86, 138752
    s_add_u32 s75, s74, 24576
    buffer_load_dwordx4 v189, s[48:51], s75 offen lds
    v_lshrrev_b32 v30, 3, v1
    v_add_u32 v30, s72, v30
    v_lshlrev_b32 v30, 10, v30
    v_and_b32 v31, 7, v1
    v_lshlrev_b32 v31, 4, v31
    s_lshl_b32 s74, s73, 1
    v_add3_u32 v30, v30, v31, s74
    buffer_load_dwordx4 v[232:235], v30, s[40:43], 0 offen
    s_barrier
    s_add_u32 s74, s101, 8
    s_cmp_ge_u32 s74, 10
    s_cselect_b32 s91, 10, 0
    s_sub_u32 s74, s74, s91
    s_lshl_b32 s74, s74, 16
    s_add_u32 s74, s74, s85
    s_add_u32 m0, s86, 114688
    s_add_u32 s75, s74, 0
    buffer_load_dwordx4 v189, s[48:51], s75 offen lds
    s_add_u32 m0, s86, 115712
    s_add_u32 s75, s74, 8192
    buffer_load_dwordx4 v189, s[48:51], s75 offen lds
    s_add_u32 m0, s86, 116736
    s_add_u32 s75, s74, 16384
    buffer_load_dwordx4 v189, s[48:51], s75 offen lds
    s_add_u32 m0, s86, 117760
    s_add_u32 s75, s74, 24576
    buffer_load_dwordx4 v189, s[48:51], s75 offen lds
    s_waitcnt vmcnt(5)
    s_barrier
    s_barrier
    s_add_u32 s74, s101, 9
    s_cmp_ge_u32 s74, 10
    s_cselect_b32 s91, 10, 0
    s_sub_u32 s74, s74, s91
    s_lshl_b32 s74, s74, 16
    s_add_u32 s74, s74, s85
    s_add_u32 m0, s86, 0
    s_add_u32 s75, s74, 0
    buffer_load_dwordx4 v189, s[48:51], s75 offen lds
    s_add_u32 m0, s86, 1024
    s_add_u32 s75, s74, 8192
    buffer_load_dwordx4 v189, s[48:51], s75 offen lds
    s_add_u32 m0, s86, 2048
    s_add_u32 s75, s74, 16384
    buffer_load_dwordx4 v189, s[48:51], s75 offen lds
    s_add_u32 m0, s86, 3072
    s_add_u32 s75, s74, 24576
    buffer_load_dwordx4 v189, s[48:51], s75 offen lds
    s_mov_b32 s74, 10
    s_lshl_b32 s74, s74, 16
    s_add_u32 s74, s74, s85
    s_add_u32 m0, s86, 16384
    s_add_u32 s75, s74, 0
    buffer_load_dwordx4 v189, s[48:51], s75 offen lds
    s_add_u32 m0, s86, 17408
    s_add_u32 s75, s74, 8192
    buffer_load_dwordx4 v189, s[48:51], s75 offen lds
    s_add_u32 m0, s86, 18432
    s_add_u32 s75, s74, 16384
    buffer_load_dwordx4 v189, s[48:51], s75 offen lds
    s_add_u32 m0, s86, 19456
    s_add_u32 s75, s74, 24576
    buffer_load_dwordx4 v189, s[48:51], s75 offen lds
    s_waitcnt vmcnt(0)
    s_barrier
    v_lshrrev_b32 v33, 3, v1
    v_mul_u32_u24 v33, 272, v33
    v_and_b32 v34, 7, v1
    v_lshl_add_u32 v33, v34, 5, v33
    v_add_u32 v33, 49152, v33
    v_lshlrev_b32 v48, 16, v232
    v_and_b32 v49, 0xffff0000, v232
    v_lshlrev_b32 v50, 16, v233
    v_and_b32 v51, 0xffff0000, v233
    v_lshlrev_b32 v52, 16, v234
    v_and_b32 v53, 0xffff0000, v234
    v_lshlrev_b32 v54, 16, v235
    v_and_b32 v55, 0xffff0000, v235
    s_barrier
    ds_read_b128 v[40:43], v33
    ds_read_b128 v[44:47], v33 offset:16
    ds_read_b128 v[56:59], v33 offset:17408
    ds_read_b128 v[60:63], v33 offset:17424
    s_waitcnt lgkmcnt(0)
    v_add_f32 v40, v40, v56
    v_add_f32 v41, v41, v57
    v_add_f32 v42, v42, v58
    v_add_f32 v43, v43, v59
    v_add_f32 v44, v44, v60
    v_add_f32 v45, v45, v61
    v_add_f32 v46, v46, v62
    v_add_f32 v47, v47, v63
    v_add_f32 v40, v40, v48
    v_add_f32 v41, v41, v49
    v_add_f32 v42, v42, v50
    v_add_f32 v43, v43, v51
    v_add_f32 v44, v44, v52
    v_add_f32 v45, v45, v53
    v_add_f32 v46, v46, v54
    v_add_f32 v47, v47, v55
    v_cvt_pk_bf16_f32 v48, v40, v41
    v_cvt_pk_bf16_f32 v49, v42, v43
    v_cvt_pk_bf16_f32 v50, v44, v45
    v_cvt_pk_bf16_f32 v51, v46, v47
    buffer_store_dwordx4 v[48:51], v30, s[56:59], 0 offen sc1 nt
    s_branch L_end
L_end:
    s_endpgm
.section .rodata,"a"
.p2align 6
.amdhsa_kernel parallel_sum__ssm_conv_s4__dense_activation_squared_relu__prompt_kernel
  .amdhsa_next_free_vgpr 256
  .amdhsa_next_free_sgpr 102
  .amdhsa_accum_offset 256
  .amdhsa_group_segment_fixed_size 0
  .amdhsa_kernarg_size 136
  .amdhsa_user_sgpr_count 2
  .amdhsa_user_sgpr_kernarg_segment_ptr 1
  .amdhsa_system_sgpr_workgroup_id_x 1
.end_amdhsa_kernel
```
